```python
import torch

def _softmax(x, axis=-1):
    return torch.softmax(x, dim=axis)
def _gelu(x):
    return torch.nn.functional.gelu(x, approximate="tanh")
def _silu(x):
    return torch.nn.functional.silu(x)
def _sigmoid(x):
    return torch.sigmoid(x)
def _layernorm(x, axis=-1, eps=1e-5):
    m = x.mean(dim=axis, keepdim=True)
    v = x.var(dim=axis, keepdim=True, unbiased=False)
    return (x - m) / torch.sqrt(v + eps)
def _scatter_add(tgt, idx, src, axis=0):
    return tgt.clone().index_add_(axis, idx, src)
def _segment_sum(src, seg, n):
    out = torch.zeros((n,) + src.shape[1:], dtype=src.dtype)
    return out.index_add_(0, seg, src)
def _pad(x, pw):
    flat = tuple(v for pair in reversed(pw) for v in pair)
    return torch.nn.functional.pad(x, flat)

kernel_name = 'recurrent_scan__sliding_block_cached__moe_arch_mod__prompt'

def setup_inputs():

    _w = (lambda a: (lambda t: t.to(torch.bfloat16) if t.is_floating_point() else t)(torch.as_tensor(a)))
    def _A_setup():
        B, Sq, D = 1, 2048, 512
        Hq, Hkv, Sk, Dh = 32, 8, 2048, 128
        assert Hq % Hkv == 0, (Hq, Hkv)
        return {
            "x": _w((lambda *s: torch.randn(*s, dtype=torch.bfloat16) * 0.05)(B, Sq, D)),
            "k_cache": _w((lambda *s: torch.randn(*s, dtype=torch.bfloat16) * 0.8)(B, Hkv, Sk, Dh)),
            "v_cache": _w((lambda *s: torch.randn(*s, dtype=torch.bfloat16) * 0.2)(B, Hkv, Sk, Dh)),
            "wq": _w((lambda *s: torch.randn(*s, dtype=torch.bfloat16) * 0.8)(D, Hq * Dh) * (D ** -0.5)),
            "wo": _w((lambda *s: torch.randn(*s, dtype=torch.bfloat16) * 0.2)(Hq * Dh, D) * ((Hq * Dh) ** -0.5)),
        }
    _A_in = _A_setup()

    def _B_setup():
        B, S, D, F, C = 1, 2048, 512, 1792, 1
        return {
            "x": _w((lambda *s: torch.randn(*s, dtype=torch.bfloat16) * 0.05)(B, S, D)),
            "w_r": _w((lambda *s: torch.randn(*s, dtype=torch.bfloat16) * 0.2)(D)),
            "w_gate": _w((lambda *s: torch.randn(*s, dtype=torch.bfloat16) * 0.1)(D, F)),
            "w_up": _w((lambda *s: torch.randn(*s, dtype=torch.bfloat16) * 0.1)(D, F)),
            "w_down": _w((lambda *s: torch.randn(*s, dtype=torch.bfloat16) * 0.1)(F, D)),
        }
    _B_in = _B_setup()

    return {
        "A_x": _A_in["x"],
        "A_k_cache": _A_in["k_cache"],
        "A_v_cache": _A_in["v_cache"],
        "A_wq": _A_in["wq"],
        "A_wo": _A_in["wo"],
        "B_x": _B_in["x"],
        "B_w_r": _B_in["w_r"],
        "B_w_gate": _B_in["w_gate"],
        "B_w_up": _B_in["w_up"],
        "B_w_down": _B_in["w_down"],
    }

def reference(A_x, A_k_cache, A_v_cache, A_wq, A_wo, B_x, B_w_r, B_w_gate, B_w_up, B_w_down):
    def _A_ref(x, k_cache, v_cache, wq, wo):
        B, Sq, D = x.shape
        Hq, Dh = 32, 128
        Hkv, Sk = k_cache.shape[1], k_cache.shape[2]
        W = min(4096, max(256, Sk // 4))
        rep = Hq // Hkv
        q = (lambda x, *d: x.permute(*d))((x @ wq).reshape(B, Sq, Hq, Dh), 0, 2, 1, 3)
        k = (lambda x, n, axis: torch.repeat_interleave(x, n, dim=axis))(k_cache[:, :, Sk - W:, :], rep, axis=1)
        v = (lambda x, n, axis: torch.repeat_interleave(x, n, dim=axis))(v_cache[:, :, Sk - W:, :], rep, axis=1)
        scores = torch.einsum("bhqd,bhkd->bhqk", q, k) * (Dh ** -0.5)
        p = _softmax(scores, axis=-1)
        o = torch.einsum("bhqk,bhkd->bhqd", p, v)
        return (lambda x, *d: x.permute(*d))(o, 0, 2, 1, 3).reshape(B, Sq, Hq * Dh) @ wo

    def _B_ref(x, w_r, w_gate, w_up, w_down):
        B, S, D = x.shape
        C = 1
        r = x @ w_r
        idx = torch.argsort(-r, axis=-1)[:, :C]
        idx_e = (lambda x, n, axis: torch.repeat_interleave(x, n, dim=axis))(idx.reshape(B, C, 1), D, axis=2)
        x_sel = (lambda x, i, axis: torch.take_along_dim(x, i, dim=axis))(x, idx_e, axis=1)
        g = _silu(x_sel @ w_gate)
        u = x_sel @ w_up
        y = (g * u) @ w_down
        r_sel = _sigmoid((lambda x, i, axis: torch.take_along_dim(x, i, dim=axis))(r, idx, axis=1))
        y = y * r_sel.reshape(B, C, 1)
        b_off = (torch.arange(B) * S).reshape(B, 1)
        flat_idx = (idx + b_off).reshape(B * C)
        zero = (x * 0.0).reshape(B * S, D)
        upd = _scatter_add(zero, flat_idx, y.reshape(B * C, D), axis=0)
        return x + upd.reshape(B, S, D)

    x = A_x
    xn = _layernorm(x, axis=-1)
    s = _A_ref(xn, A_k_cache, A_v_cache, A_wq, A_wo)
    g = _silu(_B_ref(xn, B_w_r, B_w_gate, B_w_up, B_w_down))
    return x + s * g
```

```asm
; @launch grid=(256,1,1) block=(256,1,1) lds=163840
.amdgcn_target "amdgcn-amd-amdhsa--gfx950"
.text
.globl recurrent_scan__sliding_block_cached__moe_arch_mod__prompt_kernel
.p2align 8
.type recurrent_scan__sliding_block_cached__moe_arch_mod__prompt_kernel,@function
recurrent_scan__sliding_block_cached__moe_arch_mod__prompt_kernel:
    s_cmp_ge_u32 s2, 256
    s_cbranch_scc1 L_end
    s_load_dwordx16 s[64:79], s[0:1], 0
    s_load_dwordx8 s[80:87], s[0:1], 64
    s_load_dwordx2 s[88:89], s[0:1], 96
    s_getpc_b64 s[92:93]
L_pc:
    s_sub_u32 s92, s92, L_pc-recurrent_scan__sliding_block_cached__moe_arch_mod__prompt_kernel
    s_subb_u32 s93, s93, 0
    s_lshr_b32 s94, s2, 3
    s_lshl_b32 s94, s94, 11
    v_lshlrev_b32 v2, 3, v0
    v_add_u32 v2, s94, v2
    v_min_u32 v2, L_end-recurrent_scan__sliding_block_cached__moe_arch_mod__prompt_kernel-4, v2
    global_load_dwordx2 a[252:253], v2, s[92:93]
    v_and_b32 v1, 63, v0
    v_lshrrev_b32 v2, 6, v0
    s_and_b32 s56, s2, 7
    s_lshr_b32 s3, s2, 3
    v_readfirstlane_b32 s54, v2
    s_lshr_b32 s52, s56, 1
    s_lshl_b32 s52, s52, 1
    s_and_b32 s53, s3, 1
    s_or_b32 s52, s52, s53
    s_andn2_b32 s53, s3, 1
    s_and_b32 s55, s56, 1
    s_or_b32 s53, s53, s55
    s_lshl_b32 s55, s53, 6
    s_mov_b32 s63, 0xffff0000
    s_mov_b32 s57, 0x05040100
    s_mov_b32 s58, 0x07060302
    s_mov_b32 s98, 0x3f803f80
    v_lshrrev_b32 v10, 3, v1
    v_and_b32 v11, 7, v1
    s_lshl_b32 s92, s54, 4
    s_add_u32 s93, s92, s55
    v_add_u32 v12, s93, v10
    v_lshlrev_b32 v12, 10, v12
    v_lshlrev_b32 v8, 4, v11
    v_add_u32 v16, v12, v8
    s_and_b32 s61, s52, 1
    s_lshl_b32 s61, s61, 3
    s_xor_b32 s62, s61, 8
    s_lshl_b32 s59, s62, 10
    s_lshl_b32 s60, s61, 10
    v_add_u32 v12, s92, v10
    v_mul_u32_u24 v12, 1040, v12
    v_add_u32 v12, v12, v8
    s_mul_i32 s94, s62, 1040
    s_add_u32 s94, s94, 97280
    s_mul_i32 s95, s61, 1040
    s_add_u32 s95, s95, 97280
    v_add_u32 v22, s94, v12
    v_add_u32 v23, s95, v12
    v_and_b32 v14, 15, v1
    v_lshrrev_b32 v15, 4, v1
    v_lshlrev_b32 v12, 4, v14
    v_lshlrev_b32 v13, 16, v15
    v_add_u32 v12, v12, v13
    s_lshl_b32 s92, s52, 2
    s_add_u32 s92, s92, s54
    s_lshl_b32 s92, s92, 8
    v_add_u32 v24, s92, v12
    v_add_u32 v25, 8192, v24
    v_add_u32 v26, 16384, v24
    v_add_u32 v27, 24576, v24
    v_add_u32 v28, 32768, v24
    v_add_u32 v29, 40960, v24
    v_add_u32 v30, 49152, v24
    v_add_u32 v31, 57344, v24
    v_mul_u32_u24 v12, 1040, v14
    v_lshlrev_b32 v13, 4, v15
    v_add_u32 v12, v12, v13
    v_add_u32 v7, 97280, v12
    v_lshlrev_b32 v12, 2, v15
    v_xor_b32 v12, v14, v12
    v_lshlrev_b32 v12, 4, v12
    s_lshl_b32 s92, s54, 3
    v_add_u32 v13, s92, v15
    v_lshlrev_b32 v13, 8, v13
    v_add_u32 v5, v12, v13
    v_lshlrev_b32 v12, 2, v15
    v_add_u32 v12, s54, v12
    v_lshlrev_b32 v12, 8, v12
    v_lshlrev_b32 v13, 4, v14
    v_add_u32 v6, v12, v13
    v_add_u32 v15, 4096, v6
    v_and_b32 v10, 31, v1
    v_lshrrev_b32 v11, 5, v1
    v_lshrrev_b32 v12, 2, v10
    v_mul_u32_u24 v12, 1040, v12
    v_and_b32 v13, 3, v10
    v_lshlrev_b32 v14, 8, v13
    v_add_u32 v12, v12, v14
    v_lshlrev_b32 v14, 1, v11
    v_xor_b32 v10, v14, v13
    v_lshlrev_b32 v10, 6, v10
    v_add_u32 v2, v12, v10
    v_or_b32 v14, 1, v14
    v_xor_b32 v10, v14, v13
    v_lshlrev_b32 v10, 6, v10
    v_add_u32 v3, v12, v10
    v_and_b32 v10, 15, v1
    v_lshrrev_b32 v10, 2, v10
    v_mul_u32_u24 v10, 2112, v10
    v_lshlrev_b32 v12, 8, v11
    v_add_u32 v10, v10, v12
    v_bfe_u32 v12, v1, 4, 1
    v_lshlrev_b32 v12, 1, v12
    v_and_b32 v13, 1, v1
    v_add_u32 v12, v12, v13
    v_lshlrev_b32 v12, 4, v12
    v_add_u32 v10, v10, v12
    v_bfe_u32 v12, v1, 1, 1
    v_lshlrev_b32 v12, 3, v12
    v_add_u32 v10, v10, v12
    v_add_u32 v4, 33280, v10
    s_bfe_u32 s92, s53, 0x20001
    s_cmp_eq_u32 s92, s52
    s_cselect_b32 s95, 1, 0
    s_cselect_b32 s93, 32, 0
    s_cmp_eq_u32 s54, 0
    s_cselect_b32 s93, s93, 0
    s_lshl_b32 s94, s53, 9
    s_add_u32 s94, s94, 18874368
    v_lshlrev_b32 v12, 4, v1
    v_add_u32 v12, s94, v12
    v_mov_b32 v13, 0x7ffffff0
    v_cmp_gt_u32 vcc, s93, v1
    v_mov_b32 v10, 0xff800000
    v_accvgpr_write_b32 a221, v10
    v_accvgpr_write_b32 a222, v10
    v_cndmask_b32 v9, v13, v12, vcc
    v_accvgpr_write_b32 a0, 0
    v_accvgpr_write_b32 a1, 0
    v_accvgpr_write_b32 a2, 0
    v_accvgpr_write_b32 a3, 0
    s_nop 1
    v_mfma_f32_32x32x16_bf16 a[64:79], a[0:3], a[0:3], 0
    v_mfma_f32_32x32x16_bf16 a[80:95], a[0:3], a[0:3], 0
    v_mfma_f32_32x32x16_bf16 a[96:111], a[0:3], a[0:3], 0
    v_mfma_f32_32x32x16_bf16 a[112:127], a[0:3], a[0:3], 0
    v_mfma_f32_32x32x16_bf16 a[128:143], a[0:3], a[0:3], 0
    v_mfma_f32_32x32x16_bf16 a[144:159], a[0:3], a[0:3], 0
    v_mfma_f32_32x32x16_bf16 a[160:175], a[0:3], a[0:3], 0
    v_mfma_f32_32x32x16_bf16 a[176:191], a[0:3], a[0:3], 0
    v_lshlrev_b32 v17, 4, v1
    s_lshr_b32 s92, s53, 1
    s_mul_i32 s93, s92, 32
    s_mul_i32 s94, s54, 8
    s_add_u32 s93, s93, s94
    s_lshl_b32 s96, s93, 13
    s_lshl_b32 s94, s52, 10
    s_add_u32 s96, s96, s94
    s_mul_i32 s97, s92, 8192
    s_mul_i32 s94, s54, 2048
    s_add_u32 s97, s97, s94
    s_lshl_b32 s3, s52, 19
    s_waitcnt lgkmcnt(0)
    s_mov_b32 s8, s64
    s_and_b32 s9, s65, 0xffff
    s_mov_b32 s10, 2097152
    s_mov_b32 s11, 0x20000
    buffer_load_dwordx4 v[128:131], v16, s[8:11], s59 offen offset:0
    buffer_load_dwordx4 v[132:135], v16, s[8:11], s59 offen offset:128
    buffer_load_dwordx4 v[136:139], v16, s[8:11], s59 offen offset:256
    buffer_load_dwordx4 v[140:143], v16, s[8:11], s59 offen offset:384
    buffer_load_dwordx4 v[144:147], v16, s[8:11], s59 offen offset:512
    buffer_load_dwordx4 v[148:151], v16, s[8:11], s59 offen offset:640
    buffer_load_dwordx4 v[152:155], v16, s[8:11], s59 offen offset:768
    buffer_load_dwordx4 v[156:159], v16, s[8:11], s59 offen offset:896
    buffer_load_dwordx4 v[160:163], v16, s[8:11], s60 offen offset:0
    buffer_load_dwordx4 v[164:167], v16, s[8:11], s60 offen offset:128
    buffer_load_dwordx4 v[168:171], v16, s[8:11], s60 offen offset:256
    buffer_load_dwordx4 v[172:175], v16, s[8:11], s60 offen offset:384
    buffer_load_dwordx4 v[176:179], v16, s[8:11], s60 offen offset:512
    buffer_load_dwordx4 v[180:183], v16, s[8:11], s60 offen offset:640
    buffer_load_dwordx4 v[184:187], v16, s[8:11], s60 offen offset:768
    buffer_load_dwordx4 v[188:191], v16, s[8:11], s60 offen offset:896
    s_mov_b32 s48, s70
    s_and_b32 s49, s71, 0xffff
    s_mov_b32 s50, 4194304
    s_mov_b32 s51, 0x20000
    s_add_u32 s44, s72, s3
    s_addc_u32 s45, s73, 0
    s_and_b32 s45, s45, 0xffff
    s_mov_b32 s46, 524288
    s_mov_b32 s47, 0x20000
    s_add_u32 s3, s3, 393216
    s_add_u32 s12, s66, s3
    s_addc_u32 s13, s67, 0
    s_and_b32 s13, s13, 0xffff
    s_mov_b32 s14, 131072
    s_mov_b32 s15, 0x20000
    s_sub_u32 s3, s3, 16384
    s_add_u32 s16, s68, s3
    s_addc_u32 s17, s69, 0
    s_and_b32 s17, s17, 0xffff
    s_mov_b32 s18, 147456
    s_mov_b32 s19, 0x20000
    s_mov_b32 s24, s76
    s_and_b32 s25, s77, 0xffff
    s_mov_b32 s26, 1024
    s_mov_b32 s27, 0x20000
    s_cmp_eq_u32 s95, 1
    s_cselect_b32 s26, 1024, 0
    s_mov_b32 s4, s70
    s_and_b32 s5, s71, 0xffff
    s_mov_b32 s6, 4194304
    s_mov_b32 s7, 0x20000
    s_mov_b32 s20, s88
    s_and_b32 s21, s89, 0xffff
    s_mov_b32 s22, 268435456
    s_mov_b32 s23, 0x20000
    s_or_b32 s92, s2, s54
    s_cmp_eq_u32 s92, 0
    s_mov_b32 s93, 0x7ffffff0
    s_cselect_b32 s92, 18896896, s93
    v_mov_b32 v21, s92
    s_mov_b32 s40, s86
    s_and_b32 s41, s87, 0xffff
    s_mov_b32 s42, 256
    s_mov_b32 s43, 0x20000
    s_mov_b32 s28, s78
    s_and_b32 s29, s79, 0xffff
    s_mov_b32 s30, 1835008
    s_mov_b32 s31, 0x20000
    s_mov_b32 s32, s80
    s_and_b32 s33, s81, 0xffff
    s_mov_b32 s34, 1835008
    s_mov_b32 s35, 0x20000
    s_mov_b32 s36, s82
    s_and_b32 s37, s83, 0xffff
    s_mov_b32 s38, 1835008
    s_mov_b32 s39, 0x20000
    s_mov_b32 s82, s61
    s_mov_b32 s81, s62
    s_mov_b32 s62, s95
    s_lshr_b32 s84, s2, 3
    s_lshr_b32 s83, s53, 1
    s_cmp_gt_u32 s56, 7
    s_cselect_b32 s80, 1, 0
    s_sub_u32 s80, s56, s80
    s_mul_i32 s80, s80, 32
    s_add_u32 s80, s80, s84
    s_min_u32 s80, s80, 223
    s_mov_b32 s60, 262144
    s_mov_b32 s59, 0
    s_mul_i32 s70, s54, 2080
    s_mul_i32 s71, s54, 2112
    s_add_u32 s71, s71, 33280
    s_mov_b32 s72, 0
    v_mov_b32 v14, 0
    v_mov_b32 v10, 0
    s_waitcnt vmcnt(15)
    v_dot2c_f32_bf16 v14, s98, v128
    v_dot2c_f32_bf16 v10, v128, v128
    v_dot2c_f32_bf16 v14, s98, v129
    v_dot2c_f32_bf16 v10, v129, v129
    v_dot2c_f32_bf16 v14, s98, v130
    v_dot2c_f32_bf16 v10, v130, v130
    buffer_load_dwordx4 a[252:255], v17, s[48:51], s96 offen
    s_add_u32 s96, s96, 8192
    v_dot2c_f32_bf16 v14, s98, v131
    v_dot2c_f32_bf16 v10, v131, v131
    s_waitcnt vmcnt(15)
    v_dot2c_f32_bf16 v14, s98, v132
    v_dot2c_f32_bf16 v10, v132, v132
    v_dot2c_f32_bf16 v14, s98, v133
    v_dot2c_f32_bf16 v10, v133, v133
    buffer_load_dwordx4 a[252:255], v17, s[48:51], s96 offen
    s_add_u32 s96, s96, 8192
    v_dot2c_f32_bf16 v14, s98, v134
    v_dot2c_f32_bf16 v10, v134, v134
    v_dot2c_f32_bf16 v14, s98, v135
    v_dot2c_f32_bf16 v10, v135, v135
    s_waitcnt vmcnt(15)
    v_dot2c_f32_bf16 v14, s98, v136
    v_dot2c_f32_bf16 v10, v136, v136
    v_dot2c_f32_bf16 v14, s98, v137
    buffer_load_dwordx4 a[252:255], v17, s[48:51], s96 offen
    s_add_u32 s96, s96, 8192
    v_dot2c_f32_bf16 v10, v137, v137
    v_dot2c_f32_bf16 v14, s98, v138
    v_dot2c_f32_bf16 v10, v138, v138
    v_dot2c_f32_bf16 v14, s98, v139
    v_dot2c_f32_bf16 v10, v139, v139
    s_waitcnt vmcnt(15)
    v_dot2c_f32_bf16 v14, s98, v140
    v_dot2c_f32_bf16 v10, v140, v140
    buffer_load_dwordx4 a[252:255], v17, s[48:51], s96 offen
    s_add_u32 s96, s96, 8192
    v_dot2c_f32_bf16 v14, s98, v141
    v_dot2c_f32_bf16 v10, v141, v141
    v_dot2c_f32_bf16 v14, s98, v142
    v_dot2c_f32_bf16 v10, v142, v142
    v_dot2c_f32_bf16 v14, s98, v143
    v_dot2c_f32_bf16 v10, v143, v143
    buffer_load_dwordx4 a[252:255], v17, s[48:51], s96 offen
    s_add_u32 s96, s96, 8192
    s_waitcnt vmcnt(16)
    v_dot2c_f32_bf16 v14, s98, v144
    v_dot2c_f32_bf16 v10, v144, v144
    v_dot2c_f32_bf16 v14, s98, v145
    v_dot2c_f32_bf16 v10, v145, v145
    v_dot2c_f32_bf16 v14, s98, v146
    v_dot2c_f32_bf16 v10, v146, v146
    v_dot2c_f32_bf16 v14, s98, v147
    buffer_load_dwordx4 a[252:255], v17, s[48:51], s96 offen
    s_add_u32 s96, s96, 8192
    v_dot2c_f32_bf16 v10, v147, v147
    s_waitcnt vmcnt(16)
    v_dot2c_f32_bf16 v14, s98, v148
    v_dot2c_f32_bf16 v10, v148, v148
    v_dot2c_f32_bf16 v14, s98, v149
    v_dot2c_f32_bf16 v10, v149, v149
    v_dot2c_f32_bf16 v14, s98, v150
    v_dot2c_f32_bf16 v10, v150, v150
    buffer_load_dwordx4 a[252:255], v17, s[48:51], s96 offen
    s_add_u32 s96, s96, 8192
    v_dot2c_f32_bf16 v14, s98, v151
    v_dot2c_f32_bf16 v10, v151, v151
    s_waitcnt vmcnt(16)
    v_dot2c_f32_bf16 v14, s98, v152
    v_dot2c_f32_bf16 v10, v152, v152
    v_dot2c_f32_bf16 v14, s98, v153
    v_dot2c_f32_bf16 v10, v153, v153
    buffer_load_dwordx4 a[252:255], v17, s[48:51], s96 offen
    v_dot2c_f32_bf16 v14, s98, v154
    v_dot2c_f32_bf16 v10, v154, v154
    v_dot2c_f32_bf16 v14, s98, v155
    v_dot2c_f32_bf16 v10, v155, v155
    s_waitcnt vmcnt(16)
    v_dot2c_f32_bf16 v14, s98, v156
    v_dot2c_f32_bf16 v10, v156, v156
    v_dot2c_f32_bf16 v14, s98, v157
    buffer_load_dwordx4 v[96:99], v8, s[24:27], 0 offen offset:0
    v_dot2c_f32_bf16 v10, v157, v157
    v_dot2c_f32_bf16 v14, s98, v158
    v_dot2c_f32_bf16 v10, v158, v158
    v_dot2c_f32_bf16 v14, s98, v159
    v_dot2c_f32_bf16 v10, v159, v159
    v_lshlrev_b32 v192, 16, v128
    v_and_b32 v193, s63, v128
    buffer_load_dwordx4 v[100:103], v8, s[24:27], 0 offen offset:128
    v_lshlrev_b32 v194, 16, v129
    v_and_b32 v195, s63, v129
    v_add_f32_dpp v14, v14, v14 quad_perm:[1,0,3,2] row_mask:0xf bank_mask:0xf
    v_add_f32_dpp v10, v10, v10 quad_perm:[1,0,3,2] row_mask:0xf bank_mask:0xf
    v_lshlrev_b32 v196, 16, v130
    v_and_b32 v197, s63, v130
    buffer_load_dwordx4 v[104:107], v8, s[24:27], 0 offen offset:256
    v_add_f32_dpp v14, v14, v14 quad_perm:[2,3,0,1] row_mask:0xf bank_mask:0xf
    v_add_f32_dpp v10, v10, v10 quad_perm:[2,3,0,1] row_mask:0xf bank_mask:0xf
    v_lshlrev_b32 v198, 16, v131
    v_and_b32 v199, s63, v131
    v_add_f32_dpp v14, v14, v14 row_half_mirror row_mask:0xf bank_mask:0xf
    v_add_f32_dpp v10, v10, v10 row_half_mirror row_mask:0xf bank_mask:0xf
    v_lshlrev_b32 v200, 16, v132
    buffer_load_dwordx4 v[108:111], v8, s[24:27], 0 offen offset:384
    v_and_b32 v201, s63, v132
    v_mul_f32 v14, 0x3b000000, v14
    v_mul_f32 v10, 0x3b000000, v10
    v_fma_f32 v10, -v14, v14, v10
    v_max_f32 v10, 0, v10
    v_cvt_pk_bf16_f32 v11, v14, v10
    v_lshlrev_b32 v12, 16, v11
    buffer_load_dwordx4 v[112:115], v8, s[24:27], 0 offen offset:512
    v_and_b32 v11, s63, v11
    v_add_f32 v11, 0x3727c5ac, v11
    v_cvt_pk_bf16_f32 v11, v11, v11
    v_and_b32 v11, s63, v11
    v_sqrt_f32 v11, v11
    v_sub_f32 v12, v14, v12
    buffer_load_dwordx4 v[116:119], v8, s[24:27], 0 offen offset:640
    v_cvt_pk_bf16_f32 v11, v11, v11
    v_and_b32 v11, s63, v11
    v_rcp_f32 v10, v11
    v_mov_b32 v18, v14
    v_mul_f32 v12, v12, v10
    v_mov_b32 v19, v10
    v_mov_b32 v20, v12
    buffer_load_dwordx4 v[120:123], v8, s[24:27], 0 offen offset:768
    v_fma_f32 v12, -v14, v10, v12
    v_mul_f32 v10, 0x3e0293ee, v10
    v_mul_f32 v12, 0x3e0293ee, v12
    v_lshlrev_b32 v202, 16, v133
    v_and_b32 v203, s63, v133
    v_lshlrev_b32 v204, 16, v134
    v_and_b32 v205, s63, v134
    buffer_load_dwordx4 v[124:127], v8, s[24:27], 0 offen offset:896
    v_lshlrev_b32 v206, 16, v135
    v_and_b32 v207, s63, v135
    v_lshlrev_b32 v208, 16, v136
    v_and_b32 v209, s63, v136
    v_lshlrev_b32 v210, 16, v137
    v_and_b32 v211, s63, v137
    buffer_store_dwordx4 a[0:3], v9, s[20:23], 0 offen sc0 sc1
    v_lshlrev_b32 v212, 16, v138
    v_and_b32 v213, s63, v138
    v_lshlrev_b32 v214, 16, v139
    v_and_b32 v215, s63, v139
    v_lshlrev_b32 v216, 16, v140
    v_and_b32 v217, s63, v140
    v_lshlrev_b32 v218, 16, v141
    buffer_load_dword a225, v21, s[20:23], 0 offen sc1
    v_and_b32 v219, s63, v141
    v_lshlrev_b32 v220, 16, v142
    v_and_b32 v221, s63, v142
    v_lshlrev_b32 v222, 16, v143
    v_and_b32 v223, s63, v143
    v_lshlrev_b32 v224, 16, v144
    v_and_b32 v225, s63, v144
    v_lshlrev_b32 v226, 16, v145
    v_and_b32 v227, s63, v145
    v_lshlrev_b32 v228, 16, v146
    v_and_b32 v229, s63, v146
    v_lshlrev_b32 v230, 16, v147
    v_and_b32 v231, s63, v147
    v_lshlrev_b32 v232, 16, v148
    v_and_b32 v233, s63, v148
    v_lshlrev_b32 v234, 16, v149
    v_and_b32 v235, s63, v149
    v_lshlrev_b32 v236, 16, v150
    v_and_b32 v237, s63, v150
    v_lshlrev_b32 v238, 16, v151
    v_and_b32 v239, s63, v151
    v_lshlrev_b32 v240, 16, v152
    v_and_b32 v241, s63, v152
    v_lshlrev_b32 v242, 16, v153
    v_and_b32 v243, s63, v153
    v_lshlrev_b32 v244, 16, v154
    v_and_b32 v245, s63, v154
    v_lshlrev_b32 v246, 16, v155
    v_and_b32 v247, s63, v155
    v_lshlrev_b32 v248, 16, v156
    v_and_b32 v249, s63, v156
    v_lshlrev_b32 v250, 16, v157
    v_and_b32 v251, s63, v157
    v_lshlrev_b32 v252, 16, v158
    v_and_b32 v253, s63, v158
    v_lshlrev_b32 v254, 16, v159
    v_and_b32 v255, s63, v159
    v_pk_fma_f32 v[192:193], v[192:193], v[10:11], v[12:13] op_sel_hi:[1,0,0]
    v_cvt_pk_bf16_f32 v128, v192, v193
    v_pk_fma_f32 v[194:195], v[194:195], v[10:11], v[12:13] op_sel_hi:[1,0,0]
    v_cvt_pk_bf16_f32 v129, v194, v195
    v_pk_fma_f32 v[196:197], v[196:197], v[10:11], v[12:13] op_sel_hi:[1,0,0]
    v_cvt_pk_bf16_f32 v130, v196, v197
    v_pk_fma_f32 v[198:199], v[198:199], v[10:11], v[12:13] op_sel_hi:[1,0,0]
    v_cvt_pk_bf16_f32 v131, v198, v199
    ds_write_b128 v22, v[128:131] offset:0
    v_pk_fma_f32 v[200:201], v[200:201], v[10:11], v[12:13] op_sel_hi:[1,0,0]
    v_cvt_pk_bf16_f32 v132, v200, v201
    v_pk_fma_f32 v[202:203], v[202:203], v[10:11], v[12:13] op_sel_hi:[1,0,0]
    v_cvt_pk_bf16_f32 v133, v202, v203
    v_pk_fma_f32 v[204:205], v[204:205], v[10:11], v[12:13] op_sel_hi:[1,0,0]
    v_cvt_pk_bf16_f32 v134, v204, v205
    v_pk_fma_f32 v[206:207], v[206:207], v[10:11], v[12:13] op_sel_hi:[1,0,0]
    v_cvt_pk_bf16_f32 v135, v206, v207
    ds_write_b128 v22, v[132:135] offset:128
    v_pk_fma_f32 v[208:209], v[208:209], v[10:11], v[12:13] op_sel_hi:[1,0,0]
    v_cvt_pk_bf16_f32 v136, v208, v209
    v_pk_fma_f32 v[210:211], v[210:211], v[10:11], v[12:13] op_sel_hi:[1,0,0]
    v_cvt_pk_bf16_f32 v137, v210, v211
    v_pk_fma_f32 v[212:213], v[212:213], v[10:11], v[12:13] op_sel_hi:[1,0,0]
    v_cvt_pk_bf16_f32 v138, v212, v213
    v_pk_fma_f32 v[214:215], v[214:215], v[10:11], v[12:13] op_sel_hi:[1,0,0]
    v_cvt_pk_bf16_f32 v139, v214, v215
    ds_write_b128 v22, v[136:139] offset:256
    v_pk_fma_f32 v[216:217], v[216:217], v[10:11], v[12:13] op_sel_hi:[1,0,0]
    v_cvt_pk_bf16_f32 v140, v216, v217
    v_pk_fma_f32 v[218:219], v[218:219], v[10:11], v[12:13] op_sel_hi:[1,0,0]
    v_cvt_pk_bf16_f32 v141, v218, v219
    v_pk_fma_f32 v[220:221], v[220:221], v[10:11], v[12:13] op_sel_hi:[1,0,0]
    v_cvt_pk_bf16_f32 v142, v220, v221
    v_pk_fma_f32 v[222:223], v[222:223], v[10:11], v[12:13] op_sel_hi:[1,0,0]
    v_cvt_pk_bf16_f32 v143, v222, v223
    ds_write_b128 v22, v[140:143] offset:384
    v_pk_fma_f32 v[224:225], v[224:225], v[10:11], v[12:13] op_sel_hi:[1,0,0]
    v_cvt_pk_bf16_f32 v144, v224, v225
    v_pk_fma_f32 v[226:227], v[226:227], v[10:11], v[12:13] op_sel_hi:[1,0,0]
    v_cvt_pk_bf16_f32 v145, v226, v227
    v_pk_fma_f32 v[228:229], v[228:229], v[10:11], v[12:13] op_sel_hi:[1,0,0]
    v_cvt_pk_bf16_f32 v146, v228, v229
    v_pk_fma_f32 v[230:231], v[230:231], v[10:11], v[12:13] op_sel_hi:[1,0,0]
    v_cvt_pk_bf16_f32 v147, v230, v231
    ds_write_b128 v22, v[144:147] offset:512
    v_pk_fma_f32 v[232:233], v[232:233], v[10:11], v[12:13] op_sel_hi:[1,0,0]
    v_cvt_pk_bf16_f32 v148, v232, v233
    v_pk_fma_f32 v[234:235], v[234:235], v[10:11], v[12:13] op_sel_hi:[1,0,0]
    v_cvt_pk_bf16_f32 v149, v234, v235
    v_pk_fma_f32 v[236:237], v[236:237], v[10:11], v[12:13] op_sel_hi:[1,0,0]
    v_cvt_pk_bf16_f32 v150, v236, v237
    v_pk_fma_f32 v[238:239], v[238:239], v[10:11], v[12:13] op_sel_hi:[1,0,0]
    v_cvt_pk_bf16_f32 v151, v238, v239
    ds_write_b128 v22, v[148:151] offset:640
    v_pk_fma_f32 v[240:241], v[240:241], v[10:11], v[12:13] op_sel_hi:[1,0,0]
    v_cvt_pk_bf16_f32 v152, v240, v241
    v_pk_fma_f32 v[242:243], v[242:243], v[10:11], v[12:13] op_sel_hi:[1,0,0]
    v_cvt_pk_bf16_f32 v153, v242, v243
    v_pk_fma_f32 v[244:245], v[244:245], v[10:11], v[12:13] op_sel_hi:[1,0,0]
    v_cvt_pk_bf16_f32 v154, v244, v245
    v_pk_fma_f32 v[246:247], v[246:247], v[10:11], v[12:13] op_sel_hi:[1,0,0]
    v_cvt_pk_bf16_f32 v155, v246, v247
    ds_write_b128 v22, v[152:155] offset:768
    v_pk_fma_f32 v[248:249], v[248:249], v[10:11], v[12:13] op_sel_hi:[1,0,0]
    v_cvt_pk_bf16_f32 v156, v248, v249
    v_pk_fma_f32 v[250:251], v[250:251], v[10:11], v[12:13] op_sel_hi:[1,0,0]
    v_cvt_pk_bf16_f32 v157, v250, v251
    v_pk_fma_f32 v[252:253], v[252:253], v[10:11], v[12:13] op_sel_hi:[1,0,0]
    v_cvt_pk_bf16_f32 v158, v252, v253
    v_pk_fma_f32 v[254:255], v[254:255], v[10:11], v[12:13] op_sel_hi:[1,0,0]
    v_cvt_pk_bf16_f32 v159, v254, v255
    ds_write_b128 v22, v[156:159] offset:896
    s_cmp_eq_u32 s62, 1
    s_cbranch_scc0 L_nodotA
    v_mov_b32 v17, 0
    v_mov_b32 v10, 0
    s_waitcnt vmcnt(9)
    v_dot2c_f32_bf16 v17, v128, v96
    v_dot2c_f32_bf16 v10, v129, v97
    v_dot2c_f32_bf16 v17, v130, v98
    v_dot2c_f32_bf16 v10, v131, v99
    s_waitcnt vmcnt(8)
    v_dot2c_f32_bf16 v17, v132, v100
    v_dot2c_f32_bf16 v10, v133, v101
    v_dot2c_f32_bf16 v17, v134, v102
    v_dot2c_f32_bf16 v10, v135, v103
    s_waitcnt vmcnt(7)
    v_dot2c_f32_bf16 v17, v136, v104
    v_dot2c_f32_bf16 v10, v137, v105
    v_dot2c_f32_bf16 v17, v138, v106
    v_dot2c_f32_bf16 v10, v139, v107
    s_waitcnt vmcnt(6)
    v_dot2c_f32_bf16 v17, v140, v108
    v_dot2c_f32_bf16 v10, v141, v109
    v_dot2c_f32_bf16 v17, v142, v110
    v_dot2c_f32_bf16 v10, v143, v111
    s_waitcnt vmcnt(5)
    v_dot2c_f32_bf16 v17, v144, v112
    v_dot2c_f32_bf16 v10, v145, v113
    v_dot2c_f32_bf16 v17, v146, v114
    v_dot2c_f32_bf16 v10, v147, v115
    s_waitcnt vmcnt(4)
    v_dot2c_f32_bf16 v17, v148, v116
    v_dot2c_f32_bf16 v10, v149, v117
    v_dot2c_f32_bf16 v17, v150, v118
    v_dot2c_f32_bf16 v10, v151, v119
    s_waitcnt vmcnt(3)
    v_dot2c_f32_bf16 v17, v152, v120
    v_dot2c_f32_bf16 v10, v153, v121
    v_dot2c_f32_bf16 v17, v154, v122
    v_dot2c_f32_bf16 v10, v155, v123
    s_waitcnt vmcnt(2)
    v_dot2c_f32_bf16 v17, v156, v124
    v_dot2c_f32_bf16 v10, v157, v125
    v_dot2c_f32_bf16 v17, v158, v126
    v_dot2c_f32_bf16 v10, v159, v127
    s_nop 2
    v_add_f32 v17, v17, v10
    s_nop 1
    v_add_f32_dpp v17, v17, v17 quad_perm:[1,0,3,2] row_mask:0xf bank_mask:0xf
    s_nop 1
    v_add_f32_dpp v17, v17, v17 quad_perm:[2,3,0,1] row_mask:0xf bank_mask:0xf
    s_nop 1
    v_add_f32_dpp v17, v17, v17 row_half_mirror row_mask:0xf bank_mask:0xf
L_nodotA:
    v_lshlrev_b32 v8, 4, v1
    v_mov_b32 v14, 0
    s_nop 0
    v_mov_b32 v10, 0
    s_waitcnt vmcnt(25)
    v_dot2c_f32_bf16 v14, s98, v160
    v_dot2c_f32_bf16 v10, v160, v160
    v_dot2c_f32_bf16 v14, s98, v161
    v_dot2c_f32_bf16 v10, v161, v161
    v_dot2c_f32_bf16 v14, s98, v162
    v_dot2c_f32_bf16 v10, v162, v162
    v_dot2c_f32_bf16 v14, s98, v163
    v_dot2c_f32_bf16 v10, v163, v163
    s_waitcnt vmcnt(24)
    v_dot2c_f32_bf16 v14, s98, v164
    v_dot2c_f32_bf16 v10, v164, v164
    v_dot2c_f32_bf16 v14, s98, v165
    v_dot2c_f32_bf16 v10, v165, v165
    v_dot2c_f32_bf16 v14, s98, v166
    v_dot2c_f32_bf16 v10, v166, v166
    v_dot2c_f32_bf16 v14, s98, v167
    v_dot2c_f32_bf16 v10, v167, v167
    s_waitcnt vmcnt(23)
    v_dot2c_f32_bf16 v14, s98, v168
    v_dot2c_f32_bf16 v10, v168, v168
    v_dot2c_f32_bf16 v14, s98, v169
    v_dot2c_f32_bf16 v10, v169, v169
    v_dot2c_f32_bf16 v14, s98, v170
    v_dot2c_f32_bf16 v10, v170, v170
    v_dot2c_f32_bf16 v14, s98, v171
    v_dot2c_f32_bf16 v10, v171, v171
    s_waitcnt vmcnt(22)
    v_dot2c_f32_bf16 v14, s98, v172
    v_dot2c_f32_bf16 v10, v172, v172
    v_dot2c_f32_bf16 v14, s98, v173
    v_dot2c_f32_bf16 v10, v173, v173
    v_dot2c_f32_bf16 v14, s98, v174
    v_dot2c_f32_bf16 v10, v174, v174
    v_dot2c_f32_bf16 v14, s98, v175
    v_dot2c_f32_bf16 v10, v175, v175
    s_waitcnt vmcnt(21)
    v_dot2c_f32_bf16 v14, s98, v176
    v_dot2c_f32_bf16 v10, v176, v176
    v_dot2c_f32_bf16 v14, s98, v177
    v_dot2c_f32_bf16 v10, v177, v177
    v_dot2c_f32_bf16 v14, s98, v178
    v_dot2c_f32_bf16 v10, v178, v178
    v_dot2c_f32_bf16 v14, s98, v179
    v_dot2c_f32_bf16 v10, v179, v179
    s_waitcnt vmcnt(20)
    v_dot2c_f32_bf16 v14, s98, v180
    v_dot2c_f32_bf16 v10, v180, v180
    v_dot2c_f32_bf16 v14, s98, v181
    v_dot2c_f32_bf16 v10, v181, v181
    v_dot2c_f32_bf16 v14, s98, v182
    v_dot2c_f32_bf16 v10, v182, v182
    v_dot2c_f32_bf16 v14, s98, v183
    v_dot2c_f32_bf16 v10, v183, v183
    s_waitcnt vmcnt(19)
    v_dot2c_f32_bf16 v14, s98, v184
    v_dot2c_f32_bf16 v10, v184, v184
    v_dot2c_f32_bf16 v14, s98, v185
    v_dot2c_f32_bf16 v10, v185, v185
    v_dot2c_f32_bf16 v14, s98, v186
    v_dot2c_f32_bf16 v10, v186, v186
    v_dot2c_f32_bf16 v14, s98, v187
    v_dot2c_f32_bf16 v10, v187, v187
    s_waitcnt vmcnt(18)
    v_dot2c_f32_bf16 v14, s98, v188
    v_dot2c_f32_bf16 v10, v188, v188
    v_dot2c_f32_bf16 v14, s98, v189
    v_dot2c_f32_bf16 v10, v189, v189
    v_dot2c_f32_bf16 v14, s98, v190
    v_dot2c_f32_bf16 v10, v190, v190
    v_dot2c_f32_bf16 v14, s98, v191
    v_dot2c_f32_bf16 v10, v191, v191
    v_lshlrev_b32 v192, 16, v160
    v_and_b32 v193, s63, v160
    v_lshlrev_b32 v194, 16, v161
    v_and_b32 v195, s63, v161
    v_add_f32_dpp v14, v14, v14 quad_perm:[1,0,3,2] row_mask:0xf bank_mask:0xf
    v_add_f32_dpp v10, v10, v10 quad_perm:[1,0,3,2] row_mask:0xf bank_mask:0xf
    v_lshlrev_b32 v196, 16, v162
    v_and_b32 v197, s63, v162
    v_add_f32_dpp v14, v14, v14 quad_perm:[2,3,0,1] row_mask:0xf bank_mask:0xf
    v_add_f32_dpp v10, v10, v10 quad_perm:[2,3,0,1] row_mask:0xf bank_mask:0xf
    v_lshlrev_b32 v198, 16, v163
    v_and_b32 v199, s63, v163
    v_add_f32_dpp v14, v14, v14 row_half_mirror row_mask:0xf bank_mask:0xf
    v_add_f32_dpp v10, v10, v10 row_half_mirror row_mask:0xf bank_mask:0xf
    v_lshlrev_b32 v200, 16, v164
    v_and_b32 v201, s63, v164
    v_mul_f32 v14, 0x3b000000, v14
    v_mul_f32 v10, 0x3b000000, v10
    v_fma_f32 v10, -v14, v14, v10
    v_max_f32 v10, 0, v10
    v_cvt_pk_bf16_f32 v11, v14, v10
    v_lshlrev_b32 v12, 16, v11
    v_and_b32 v11, s63, v11
    v_add_f32 v11, 0x3727c5ac, v11
    v_cvt_pk_bf16_f32 v11, v11, v11
    v_and_b32 v11, s63, v11
    v_sqrt_f32 v11, v11
    v_sub_f32 v12, v14, v12
    v_cvt_pk_bf16_f32 v11, v11, v11
    v_and_b32 v11, s63, v11
    v_rcp_f32 v10, v11
    v_mov_b32 v18, v14
    v_mul_f32 v12, v12, v10
    v_mov_b32 v19, v10
    v_mov_b32 v20, v12
    v_fma_f32 v12, -v14, v10, v12
    v_mul_f32 v10, 0x3e0293ee, v10
    v_mul_f32 v12, 0x3e0293ee, v12
    v_lshlrev_b32 v202, 16, v165
    v_and_b32 v203, s63, v165
    v_lshlrev_b32 v204, 16, v166
    v_and_b32 v205, s63, v166
    v_lshlrev_b32 v206, 16, v167
    v_and_b32 v207, s63, v167
    v_lshlrev_b32 v208, 16, v168
    v_and_b32 v209, s63, v168
    v_lshlrev_b32 v210, 16, v169
    v_and_b32 v211, s63, v169
    v_lshlrev_b32 v212, 16, v170
    v_and_b32 v213, s63, v170
    v_lshlrev_b32 v214, 16, v171
    v_and_b32 v215, s63, v171
    v_lshlrev_b32 v216, 16, v172
    v_and_b32 v217, s63, v172
    v_lshlrev_b32 v218, 16, v173
    v_and_b32 v219, s63, v173
    v_lshlrev_b32 v220, 16, v174
    v_and_b32 v221, s63, v174
    v_lshlrev_b32 v222, 16, v175
    v_and_b32 v223, s63, v175
    v_lshlrev_b32 v224, 16, v176
    v_and_b32 v225, s63, v176
    v_lshlrev_b32 v226, 16, v177
    v_and_b32 v227, s63, v177
    v_lshlrev_b32 v228, 16, v178
    v_and_b32 v229, s63, v178
    v_lshlrev_b32 v230, 16, v179
    v_and_b32 v231, s63, v179
    v_lshlrev_b32 v232, 16, v180
    v_and_b32 v233, s63, v180
    v_lshlrev_b32 v234, 16, v181
    v_and_b32 v235, s63, v181
    v_lshlrev_b32 v236, 16, v182
    v_and_b32 v237, s63, v182
    v_lshlrev_b32 v238, 16, v183
    v_and_b32 v239, s63, v183
    v_lshlrev_b32 v240, 16, v184
    v_and_b32 v241, s63, v184
    v_lshlrev_b32 v242, 16, v185
    v_and_b32 v243, s63, v185
    v_lshlrev_b32 v244, 16, v186
    v_and_b32 v245, s63, v186
    v_lshlrev_b32 v246, 16, v187
    v_and_b32 v247, s63, v187
    buffer_load_dwordx4 v[32:35], v24, s[4:7], s59 offen
    v_lshlrev_b32 v248, 16, v188
    v_and_b32 v249, s63, v188
    v_lshlrev_b32 v250, 16, v189
    v_and_b32 v251, s63, v189
    v_lshlrev_b32 v252, 16, v190
    v_and_b32 v253, s63, v190
    v_lshlrev_b32 v254, 16, v191
    v_and_b32 v255, s63, v191
    v_pk_fma_f32 v[192:193], v[192:193], v[10:11], v[12:13] op_sel_hi:[1,0,0]
    buffer_load_dwordx4 v[36:39], v25, s[4:7], s59 offen
    v_cvt_pk_bf16_f32 v160, v192, v193
    v_pk_fma_f32 v[194:195], v[194:195], v[10:11], v[12:13] op_sel_hi:[1,0,0]
    v_cvt_pk_bf16_f32 v161, v194, v195
    v_pk_fma_f32 v[196:197], v[196:197], v[10:11], v[12:13] op_sel_hi:[1,0,0]
    v_cvt_pk_bf16_f32 v162, v196, v197
    v_pk_fma_f32 v[198:199], v[198:199], v[10:11], v[12:13] op_sel_hi:[1,0,0]
    v_cvt_pk_bf16_f32 v163, v198, v199
    ds_write_b128 v23, v[160:163] offset:0
    v_pk_fma_f32 v[200:201], v[200:201], v[10:11], v[12:13] op_sel_hi:[1,0,0]
    buffer_load_dwordx4 v[40:43], v26, s[4:7], s59 offen
    v_cvt_pk_bf16_f32 v164, v200, v201
    v_pk_fma_f32 v[202:203], v[202:203], v[10:11], v[12:13] op_sel_hi:[1,0,0]
    v_cvt_pk_bf16_f32 v165, v202, v203
    v_pk_fma_f32 v[204:205], v[204:205], v[10:11], v[12:13] op_sel_hi:[1,0,0]
    v_cvt_pk_bf16_f32 v166, v204, v205
    v_pk_fma_f32 v[206:207], v[206:207], v[10:11], v[12:13] op_sel_hi:[1,0,0]
    v_cvt_pk_bf16_f32 v167, v206, v207
    ds_write_b128 v23, v[164:167] offset:128
    v_pk_fma_f32 v[208:209], v[208:209], v[10:11], v[12:13] op_sel_hi:[1,0,0]
    buffer_load_dwordx4 v[44:47], v27, s[4:7], s59 offen
    v_cvt_pk_bf16_f32 v168, v208, v209
    v_pk_fma_f32 v[210:211], v[210:211], v[10:11], v[12:13] op_sel_hi:[1,0,0]
    v_cvt_pk_bf16_f32 v169, v210, v211
    v_pk_fma_f32 v[212:213], v[212:213], v[10:11], v[12:13] op_sel_hi:[1,0,0]
    v_cvt_pk_bf16_f32 v170, v212, v213
    v_pk_fma_f32 v[214:215], v[214:215], v[10:11], v[12:13] op_sel_hi:[1,0,0]
    v_cvt_pk_bf16_f32 v171, v214, v215
    ds_write_b128 v23, v[168:171] offset:256
    v_pk_fma_f32 v[216:217], v[216:217], v[10:11], v[12:13] op_sel_hi:[1,0,0]
    buffer_load_dwordx4 v[48:51], v28, s[4:7], s59 offen
    v_cvt_pk_bf16_f32 v172, v216, v217
    v_pk_fma_f32 v[218:219], v[218:219], v[10:11], v[12:13] op_sel_hi:[1,0,0]
    v_cvt_pk_bf16_f32 v173, v218, v219
    v_pk_fma_f32 v[220:221], v[220:221], v[10:11], v[12:13] op_sel_hi:[1,0,0]
    v_cvt_pk_bf16_f32 v174, v220, v221
    v_pk_fma_f32 v[222:223], v[222:223], v[10:11], v[12:13] op_sel_hi:[1,0,0]
    v_cvt_pk_bf16_f32 v175, v222, v223
    ds_write_b128 v23, v[172:175] offset:384
    v_pk_fma_f32 v[224:225], v[224:225], v[10:11], v[12:13] op_sel_hi:[1,0,0]
    buffer_load_dwordx4 v[52:55], v29, s[4:7], s59 offen
    v_cvt_pk_bf16_f32 v176, v224, v225
    v_pk_fma_f32 v[226:227], v[226:227], v[10:11], v[12:13] op_sel_hi:[1,0,0]
    v_cvt_pk_bf16_f32 v177, v226, v227
    v_pk_fma_f32 v[228:229], v[228:229], v[10:11], v[12:13] op_sel_hi:[1,0,0]
    v_cvt_pk_bf16_f32 v178, v228, v229
    v_pk_fma_f32 v[230:231], v[230:231], v[10:11], v[12:13] op_sel_hi:[1,0,0]
    v_cvt_pk_bf16_f32 v179, v230, v231
    ds_write_b128 v23, v[176:179] offset:512
    v_pk_fma_f32 v[232:233], v[232:233], v[10:11], v[12:13] op_sel_hi:[1,0,0]
    buffer_load_dwordx4 v[56:59], v30, s[4:7], s59 offen
    v_cvt_pk_bf16_f32 v180, v232, v233
    v_pk_fma_f32 v[234:235], v[234:235], v[10:11], v[12:13] op_sel_hi:[1,0,0]
    v_cvt_pk_bf16_f32 v181, v234, v235
    v_pk_fma_f32 v[236:237], v[236:237], v[10:11], v[12:13] op_sel_hi:[1,0,0]
    v_cvt_pk_bf16_f32 v182, v236, v237
    v_pk_fma_f32 v[238:239], v[238:239], v[10:11], v[12:13] op_sel_hi:[1,0,0]
    v_cvt_pk_bf16_f32 v183, v238, v239
    ds_write_b128 v23, v[180:183] offset:640
    v_pk_fma_f32 v[240:241], v[240:241], v[10:11], v[12:13] op_sel_hi:[1,0,0]
    buffer_load_dwordx4 v[60:63], v31, s[4:7], s59 offen
    s_add_u32 s59, s59, s60
    v_cvt_pk_bf16_f32 v184, v240, v241
    v_pk_fma_f32 v[242:243], v[242:243], v[10:11], v[12:13] op_sel_hi:[1,0,0]
    v_cvt_pk_bf16_f32 v185, v242, v243
    v_pk_fma_f32 v[244:245], v[244:245], v[10:11], v[12:13] op_sel_hi:[1,0,0]
    v_cvt_pk_bf16_f32 v186, v244, v245
    v_pk_fma_f32 v[246:247], v[246:247], v[10:11], v[12:13] op_sel_hi:[1,0,0]
    v_cvt_pk_bf16_f32 v187, v246, v247
    ds_write_b128 v23, v[184:187] offset:768
    v_pk_fma_f32 v[248:249], v[248:249], v[10:11], v[12:13] op_sel_hi:[1,0,0]
    v_cvt_pk_bf16_f32 v188, v248, v249
    v_pk_fma_f32 v[250:251], v[250:251], v[10:11], v[12:13] op_sel_hi:[1,0,0]
    v_cvt_pk_bf16_f32 v189, v250, v251
    v_pk_fma_f32 v[252:253], v[252:253], v[10:11], v[12:13] op_sel_hi:[1,0,0]
    v_cvt_pk_bf16_f32 v190, v252, v253
    v_pk_fma_f32 v[254:255], v[254:255], v[10:11], v[12:13] op_sel_hi:[1,0,0]
    v_cvt_pk_bf16_f32 v191, v254, v255
    ds_write_b128 v23, v[188:191] offset:896
    buffer_load_dwordx4 v[64:67], v24, s[4:7], s59 offen
    buffer_load_dwordx4 v[68:71], v25, s[4:7], s59 offen
    buffer_load_dwordx4 v[72:75], v26, s[4:7], s59 offen
    buffer_load_dwordx4 v[76:79], v27, s[4:7], s59 offen
    buffer_load_dwordx4 v[80:83], v28, s[4:7], s59 offen
    buffer_load_dwordx4 v[84:87], v29, s[4:7], s59 offen
    buffer_load_dwordx4 v[88:91], v30, s[4:7], s59 offen
    buffer_load_dwordx4 v[92:95], v31, s[4:7], s59 offen
    s_add_u32 s59, s59, s60
    s_lshr_b32 s73, s52, 1
    s_cmp_eq_u32 s73, s54
    s_cbranch_scc0 L_nostat
    v_lshrrev_b32 v10, 3, v1
    v_lshlrev_b32 v10, 4, v10
    v_add_u32 v10, 67328, v10
    ds_write_b96 v10, v[18:20]
L_nostat:
    s_cmp_eq_u32 s62, 1
    s_cbranch_scc0 L_nodotB
    v_mov_b32 v21, 0
    v_mov_b32 v10, 0
    s_waitcnt vmcnt(25)
    v_dot2c_f32_bf16 v21, v160, v96
    v_dot2c_f32_bf16 v10, v161, v97
    v_dot2c_f32_bf16 v21, v162, v98
    v_dot2c_f32_bf16 v10, v163, v99
    s_waitcnt vmcnt(24)
    v_dot2c_f32_bf16 v21, v164, v100
    v_dot2c_f32_bf16 v10, v165, v101
    v_dot2c_f32_bf16 v21, v166, v102
    v_dot2c_f32_bf16 v10, v167, v103
    s_waitcnt vmcnt(23)
    v_dot2c_f32_bf16 v21, v168, v104
    v_dot2c_f32_bf16 v10, v169, v105
    v_dot2c_f32_bf16 v21, v170, v106
    v_dot2c_f32_bf16 v10, v171, v107
    s_waitcnt vmcnt(22)
    v_dot2c_f32_bf16 v21, v172, v108
    v_dot2c_f32_bf16 v10, v173, v109
    v_dot2c_f32_bf16 v21, v174, v110
    v_dot2c_f32_bf16 v10, v175, v111
    s_waitcnt vmcnt(21)
    v_dot2c_f32_bf16 v21, v176, v112
    v_dot2c_f32_bf16 v10, v177, v113
    v_dot2c_f32_bf16 v21, v178, v114
    v_dot2c_f32_bf16 v10, v179, v115
    s_waitcnt vmcnt(20)
    v_dot2c_f32_bf16 v21, v180, v116
    v_dot2c_f32_bf16 v10, v181, v117
    v_dot2c_f32_bf16 v21, v182, v118
    v_dot2c_f32_bf16 v10, v183, v119
    s_waitcnt vmcnt(19)
    v_dot2c_f32_bf16 v21, v184, v120
    v_dot2c_f32_bf16 v10, v185, v121
    v_dot2c_f32_bf16 v21, v186, v122
    v_dot2c_f32_bf16 v10, v187, v123
    s_waitcnt vmcnt(18)
    v_dot2c_f32_bf16 v21, v188, v124
    v_dot2c_f32_bf16 v10, v189, v125
    v_dot2c_f32_bf16 v21, v190, v126
    v_dot2c_f32_bf16 v10, v191, v127
    s_nop 2
    v_add_f32 v21, v21, v10
    s_nop 1
    v_add_f32_dpp v21, v21, v21 quad_perm:[1,0,3,2] row_mask:0xf bank_mask:0xf
    s_nop 1
    v_add_f32_dpp v21, v21, v21 quad_perm:[2,3,0,1] row_mask:0xf bank_mask:0xf
    s_nop 1
    v_add_f32_dpp v21, v21, v21 row_half_mirror row_mask:0xf bank_mask:0xf
    v_lshrrev_b32 v11, 10, v16
    v_mul_f32 v17, 0x40faf233, v17
    v_cvt_pk_bf16_f32 v17, v17, v17
    v_and_b32 v17, 0xffff, v17
    v_lshrrev_b32 v10, 15, v17
    v_mul_u32_u24 v10, 0x7fff, v10
    v_xor_b32 v17, v17, v10
    v_xor_b32 v17, 0x8000, v17
    v_lshlrev_b32 v17, 16, v17
    v_add_u32 v10, s81, v11
    v_sub_u32 v10, 0xffff, v10
    v_or_b32 v17, v17, v10
    v_mul_f32 v21, 0x40faf233, v21
    v_cvt_pk_bf16_f32 v21, v21, v21
    v_and_b32 v21, 0xffff, v21
    v_lshrrev_b32 v10, 15, v21
    v_mul_u32_u24 v10, 0x7fff, v10
    v_xor_b32 v21, v21, v10
    v_xor_b32 v21, 0x8000, v21
    v_lshlrev_b32 v21, 16, v21
    v_add_u32 v10, s82, v11
    v_sub_u32 v10, 0xffff, v10
    v_or_b32 v21, v21, v10
    v_max_u32 v17, v17, v21
    s_nop 1
    v_max_u32_dpp v17, v17, v17 row_ror:8 row_mask:0xf bank_mask:0xf
    v_mov_b32 v11, v17
    s_nop 1
    v_permlane16_swap_b32 v17, v11
    v_max_u32 v17, v17, v11
    v_mov_b32 v11, v17
    s_nop 1
    v_permlane32_swap_b32 v17, v11
    v_max_u32 v17, v17, v11
L_nodotB:
    s_lshl_b32 s73, s54, 2
    s_add_u32 s73, s73, 66832
    v_mov_b32 v11, s73
    ds_write_b32 v11, v17
    s_waitcnt lgkmcnt(0)
    s_barrier
    v_mov_b32 v12, 66832
    ds_read_b128 v[8:11], v12
    s_mov_b32 s99, 0
L_gemm:
    ds_read_b128 a[0:3], v7 offset:0
    ds_read_b128 a[4:7], v7 offset:16640
    ds_read_b128 a[8:11], v7 offset:33280
    ds_read_b128 a[12:15], v7 offset:49920
    s_waitcnt vmcnt(8)
    v_perm_b32 v16, v36, v32, s57
    v_perm_b32 v17, v44, v40, s57
    v_perm_b32 v18, v52, v48, s57
    v_perm_b32 v19, v60, v56, s57
    s_waitcnt lgkmcnt(0)
    s_nop 0
    v_mfma_f32_16x16x32_bf16 v[128:131], v[16:19], a[0:3], 0
    v_perm_b32 v20, v36, v32, s58
    v_perm_b32 v21, v44, v40, s58
    v_mfma_f32_16x16x32_bf16 v[132:135], v[16:19], a[4:7], 0
    v_perm_b32 v22, v52, v48, s58
    v_perm_b32 v23, v60, v56, s58
    v_mfma_f32_16x16x32_bf16 v[136:139], v[16:19], a[8:11], 0
    buffer_load_dwordx4 v[96:99], v24, s[4:7], s59 offen
    v_mfma_f32_16x16x32_bf16 v[140:143], v[16:19], a[12:15], 0
    ds_read_b128 a[16:19], v7 offset:64
    v_mfma_f32_16x16x32_bf16 v[144:147], v[20:23], a[0:3], 0
    v_perm_b32 v16, v37, v33, s57
    v_perm_b32 v17, v45, v41, s57
    v_mfma_f32_16x16x32_bf16 v[148:151], v[20:23], a[4:7], 0
    v_perm_b32 v18, v53, v49, s57
    v_perm_b32 v19, v61, v57, s57
    v_mfma_f32_16x16x32_bf16 v[152:155], v[20:23], a[8:11], 0
    buffer_load_dwordx4 v[100:103], v25, s[4:7], s59 offen
    v_mfma_f32_16x16x32_bf16 v[156:159], v[20:23], a[12:15], 0
    ds_read_b128 a[20:23], v7 offset:16704
    v_mfma_f32_16x16x32_bf16 v[160:163], v[16:19], a[0:3], 0
    v_perm_b32 v20, v37, v33, s58
    v_perm_b32 v21, v45, v41, s58
    v_mfma_f32_16x16x32_bf16 v[164:167], v[16:19], a[4:7], 0
    v_perm_b32 v22, v53, v49, s58
    v_perm_b32 v23, v61, v57, s58
    v_mfma_f32_16x16x32_bf16 v[168:171], v[16:19], a[8:11], 0
    buffer_load_dwordx4 v[104:107], v26, s[4:7], s59 offen
    v_mfma_f32_16x16x32_bf16 v[172:175], v[16:19], a[12:15], 0
    ds_read_b128 a[24:27], v7 offset:33344
    v_mfma_f32_16x16x32_bf16 v[176:179], v[20:23], a[0:3], 0
    v_perm_b32 v16, v38, v34, s57
    v_perm_b32 v17, v46, v42, s57
    v_mfma_f32_16x16x32_bf16 v[180:183], v[20:23], a[4:7], 0
    v_perm_b32 v18, v54, v50, s57
    v_perm_b32 v19, v62, v58, s57
    v_mfma_f32_16x16x32_bf16 v[184:187], v[20:23], a[8:11], 0
    buffer_load_dwordx4 v[108:111], v27, s[4:7], s59 offen
    v_mfma_f32_16x16x32_bf16 v[188:191], v[20:23], a[12:15], 0
    ds_read_b128 a[28:31], v7 offset:49984
    v_mfma_f32_16x16x32_bf16 v[192:195], v[16:19], a[0:3], 0
    v_perm_b32 v20, v38, v34, s58
    v_perm_b32 v21, v46, v42, s58
    v_mfma_f32_16x16x32_bf16 v[196:199], v[16:19], a[4:7], 0
    v_perm_b32 v22, v54, v50, s58
    v_perm_b32 v23, v62, v58, s58
    v_mfma_f32_16x16x32_bf16 v[200:203], v[16:19], a[8:11], 0
    buffer_load_dwordx4 v[112:115], v28, s[4:7], s59 offen
    v_mfma_f32_16x16x32_bf16 v[204:207], v[16:19], a[12:15], 0
    v_mfma_f32_16x16x32_bf16 v[208:211], v[20:23], a[0:3], 0
    v_perm_b32 v16, v39, v35, s57
    v_perm_b32 v17, v47, v43, s57
    v_mfma_f32_16x16x32_bf16 v[212:215], v[20:23], a[4:7], 0
    v_perm_b32 v18, v55, v51, s57
    v_perm_b32 v19, v63, v59, s57
    v_mfma_f32_16x16x32_bf16 v[216:219], v[20:23], a[8:11], 0
    buffer_load_dwordx4 v[116:119], v29, s[4:7], s59 offen
    v_mfma_f32_16x16x32_bf16 v[220:223], v[20:23], a[12:15], 0
    v_mfma_f32_16x16x32_bf16 v[224:227], v[16:19], a[0:3], 0
    v_perm_b32 v20, v39, v35, s58
    v_perm_b32 v21, v47, v43, s58
    v_mfma_f32_16x16x32_bf16 v[228:231], v[16:19], a[4:7], 0
    v_perm_b32 v22, v55, v51, s58
    v_perm_b32 v23, v63, v59, s58
    v_mfma_f32_16x16x32_bf16 v[232:235], v[16:19], a[8:11], 0
    buffer_load_dwordx4 v[120:123], v30, s[4:7], s59 offen
    v_mfma_f32_16x16x32_bf16 v[236:239], v[16:19], a[12:15], 0
    s_waitcnt vmcnt(7)
    v_mfma_f32_16x16x32_bf16 v[240:243], v[20:23], a[0:3], 0
    v_perm_b32 v16, v68, v64, s57
    v_perm_b32 v17, v76, v72, s57
    v_mfma_f32_16x16x32_bf16 v[244:247], v[20:23], a[4:7], 0
    v_perm_b32 v18, v84, v80, s57
    v_perm_b32 v19, v92, v88, s57
    v_mfma_f32_16x16x32_bf16 v[248:251], v[20:23], a[8:11], 0
    buffer_load_dwordx4 v[124:127], v31, s[4:7], s59 offen
    v_mfma_f32_16x16x32_bf16 v[252:255], v[20:23], a[12:15], 0
    s_add_u32 s59, s59, s60
    s_waitcnt lgkmcnt(0)
    s_mov_b32 s61, 0
L_gq:
    v_mfma_f32_16x16x32_bf16 v[128:131], v[16:19], a[16:19], v[128:131]
    v_perm_b32 v20, v68, v64, s58
    v_perm_b32 v21, v76, v72, s58
    v_mfma_f32_16x16x32_bf16 v[132:135], v[16:19], a[20:23], v[132:135]
    v_perm_b32 v22, v84, v80, s58
    v_perm_b32 v23, v92, v88, s58
    v_mfma_f32_16x16x32_bf16 v[136:139], v[16:19], a[24:27], v[136:139]
    buffer_load_dwordx4 v[32:35], v24, s[4:7], s59 offen
    v_mfma_f32_16x16x32_bf16 v[140:143], v[16:19], a[28:31], v[140:143]
    ds_read_b128 a[32:35], v7 offset:128
    v_mfma_f32_16x16x32_bf16 v[144:147], v[20:23], a[16:19], v[144:147]
    v_perm_b32 v16, v69, v65, s57
    v_perm_b32 v17, v77, v73, s57
    v_mfma_f32_16x16x32_bf16 v[148:151], v[20:23], a[20:23], v[148:151]
    v_perm_b32 v18, v85, v81, s57
    v_perm_b32 v19, v93, v89, s57
    v_mfma_f32_16x16x32_bf16 v[152:155], v[20:23], a[24:27], v[152:155]
    buffer_load_dwordx4 v[36:39], v25, s[4:7], s59 offen
    v_mfma_f32_16x16x32_bf16 v[156:159], v[20:23], a[28:31], v[156:159]
    ds_read_b128 a[36:39], v7 offset:16768
    v_mfma_f32_16x16x32_bf16 v[160:163], v[16:19], a[16:19], v[160:163]
    v_perm_b32 v20, v69, v65, s58
    v_perm_b32 v21, v77, v73, s58
    v_mfma_f32_16x16x32_bf16 v[164:167], v[16:19], a[20:23], v[164:167]
    v_perm_b32 v22, v85, v81, s58
    v_perm_b32 v23, v93, v89, s58
    v_mfma_f32_16x16x32_bf16 v[168:171], v[16:19], a[24:27], v[168:171]
    buffer_load_dwordx4 v[40:43], v26, s[4:7], s59 offen
    v_mfma_f32_16x16x32_bf16 v[172:175], v[16:19], a[28:31], v[172:175]
    ds_read_b128 a[40:43], v7 offset:33408
    v_mfma_f32_16x16x32_bf16 v[176:179], v[20:23], a[16:19], v[176:179]
    v_perm_b32 v16, v70, v66, s57
    v_perm_b32 v17, v78, v74, s57
    v_mfma_f32_16x16x32_bf16 v[180:183], v[20:23], a[20:23], v[180:183]
    v_perm_b32 v18, v86, v82, s57
    v_perm_b32 v19, v94, v90, s57
    v_mfma_f32_16x16x32_bf16 v[184:187], v[20:23], a[24:27], v[184:187]
    buffer_load_dwordx4 v[44:47], v27, s[4:7], s59 offen
    v_mfma_f32_16x16x32_bf16 v[188:191], v[20:23], a[28:31], v[188:191]
    ds_read_b128 a[44:47], v7 offset:50048
    v_mfma_f32_16x16x32_bf16 v[192:195], v[16:19], a[16:19], v[192:195]
    v_perm_b32 v20, v70, v66, s58
    v_perm_b32 v21, v78, v74, s58
    v_mfma_f32_16x16x32_bf16 v[196:199], v[16:19], a[20:23], v[196:199]
    v_perm_b32 v22, v86, v82, s58
    v_perm_b32 v23, v94, v90, s58
    v_mfma_f32_16x16x32_bf16 v[200:203], v[16:19], a[24:27], v[200:203]
    buffer_load_dwordx4 v[48:51], v28, s[4:7], s59 offen
    v_mfma_f32_16x16x32_bf16 v[204:207], v[16:19], a[28:31], v[204:207]
    v_mfma_f32_16x16x32_bf16 v[208:211], v[20:23], a[16:19], v[208:211]
    v_perm_b32 v16, v71, v67, s57
    v_perm_b32 v17, v79, v75, s57
    v_mfma_f32_16x16x32_bf16 v[212:215], v[20:23], a[20:23], v[212:215]
    v_perm_b32 v18, v87, v83, s57
    v_perm_b32 v19, v95, v91, s57
    v_mfma_f32_16x16x32_bf16 v[216:219], v[20:23], a[24:27], v[216:219]
    buffer_load_dwordx4 v[52:55], v29, s[4:7], s59 offen
    v_mfma_f32_16x16x32_bf16 v[220:223], v[20:23], a[28:31], v[220:223]
    v_mfma_f32_16x16x32_bf16 v[224:227], v[16:19], a[16:19], v[224:227]
    v_perm_b32 v20, v71, v67, s58
    v_perm_b32 v21, v79, v75, s58
    v_mfma_f32_16x16x32_bf16 v[228:231], v[16:19], a[20:23], v[228:231]
    v_perm_b32 v22, v87, v83, s58
    v_perm_b32 v23, v95, v91, s58
    v_mfma_f32_16x16x32_bf16 v[232:235], v[16:19], a[24:27], v[232:235]
    buffer_load_dwordx4 v[56:59], v30, s[4:7], s59 offen
    v_mfma_f32_16x16x32_bf16 v[236:239], v[16:19], a[28:31], v[236:239]
    s_waitcnt vmcnt(7)
    v_mfma_f32_16x16x32_bf16 v[240:243], v[20:23], a[16:19], v[240:243]
    v_perm_b32 v16, v100, v96, s57
    v_perm_b32 v17, v108, v104, s57
    v_mfma_f32_16x16x32_bf16 v[244:247], v[20:23], a[20:23], v[244:247]
    v_perm_b32 v18, v116, v112, s57
    v_perm_b32 v19, v124, v120, s57
    v_mfma_f32_16x16x32_bf16 v[248:251], v[20:23], a[24:27], v[248:251]
    buffer_load_dwordx4 v[60:63], v31, s[4:7], s59 offen
    v_mfma_f32_16x16x32_bf16 v[252:255], v[20:23], a[28:31], v[252:255]
    s_add_u32 s59, s59, s60
    s_waitcnt lgkmcnt(0)
    v_mfma_f32_16x16x32_bf16 v[128:131], v[16:19], a[32:35], v[128:131]
    v_perm_b32 v20, v100, v96, s58
    v_perm_b32 v21, v108, v104, s58
    v_mfma_f32_16x16x32_bf16 v[132:135], v[16:19], a[36:39], v[132:135]
    v_perm_b32 v22, v116, v112, s58
    v_perm_b32 v23, v124, v120, s58
    v_mfma_f32_16x16x32_bf16 v[136:139], v[16:19], a[40:43], v[136:139]
    buffer_load_dwordx4 v[64:67], v24, s[4:7], s59 offen
    v_mfma_f32_16x16x32_bf16 v[140:143], v[16:19], a[44:47], v[140:143]
    ds_read_b128 a[0:3], v7 offset:192
    v_mfma_f32_16x16x32_bf16 v[144:147], v[20:23], a[32:35], v[144:147]
    v_perm_b32 v16, v101, v97, s57
    v_perm_b32 v17, v109, v105, s57
    v_mfma_f32_16x16x32_bf16 v[148:151], v[20:23], a[36:39], v[148:151]
    v_perm_b32 v18, v117, v113, s57
    v_perm_b32 v19, v125, v121, s57
    v_mfma_f32_16x16x32_bf16 v[152:155], v[20:23], a[40:43], v[152:155]
    buffer_load_dwordx4 v[68:71], v25, s[4:7], s59 offen
    v_mfma_f32_16x16x32_bf16 v[156:159], v[20:23], a[44:47], v[156:159]
    ds_read_b128 a[4:7], v7 offset:16832
    v_mfma_f32_16x16x32_bf16 v[160:163], v[16:19], a[32:35], v[160:163]
    v_perm_b32 v20, v101, v97, s58
    v_perm_b32 v21, v109, v105, s58
    v_mfma_f32_16x16x32_bf16 v[164:167], v[16:19], a[36:39], v[164:167]
    v_perm_b32 v22, v117, v113, s58
    v_perm_b32 v23, v125, v121, s58
    v_mfma_f32_16x16x32_bf16 v[168:171], v[16:19], a[40:43], v[168:171]
    buffer_load_dwordx4 v[72:75], v26, s[4:7], s59 offen
    v_mfma_f32_16x16x32_bf16 v[172:175], v[16:19], a[44:47], v[172:175]
    ds_read_b128 a[8:11], v7 offset:33472
    v_mfma_f32_16x16x32_bf16 v[176:179], v[20:23], a[32:35], v[176:179]
    v_perm_b32 v16, v102, v98, s57
    v_perm_b32 v17, v110, v106, s57
    v_mfma_f32_16x16x32_bf16 v[180:183], v[20:23], a[36:39], v[180:183]
    v_perm_b32 v18, v118, v114, s57
    v_perm_b32 v19, v126, v122, s57
    v_mfma_f32_16x16x32_bf16 v[184:187], v[20:23], a[40:43], v[184:187]
    buffer_load_dwordx4 v[76:79], v27, s[4:7], s59 offen
    v_mfma_f32_16x16x32_bf16 v[188:191], v[20:23], a[44:47], v[188:191]
    ds_read_b128 a[12:15], v7 offset:50112
    v_mfma_f32_16x16x32_bf16 v[192:195], v[16:19], a[32:35], v[192:195]
    v_perm_b32 v20, v102, v98, s58
    v_perm_b32 v21, v110, v106, s58
    v_mfma_f32_16x16x32_bf16 v[196:199], v[16:19], a[36:39], v[196:199]
    v_perm_b32 v22, v118, v114, s58
    v_perm_b32 v23, v126, v122, s58
    v_mfma_f32_16x16x32_bf16 v[200:203], v[16:19], a[40:43], v[200:203]
    buffer_load_dwordx4 v[80:83], v28, s[4:7], s59 offen
    v_mfma_f32_16x16x32_bf16 v[204:207], v[16:19], a[44:47], v[204:207]
    v_mfma_f32_16x16x32_bf16 v[208:211], v[20:23], a[32:35], v[208:211]
    v_perm_b32 v16, v103, v99, s57
    v_perm_b32 v17, v111, v107, s57
    v_mfma_f32_16x16x32_bf16 v[212:215], v[20:23], a[36:39], v[212:215]
    v_perm_b32 v18, v119, v115, s57
    v_perm_b32 v19, v127, v123, s57
    v_mfma_f32_16x16x32_bf16 v[216:219], v[20:23], a[40:43], v[216:219]
    buffer_load_dwordx4 v[84:87], v29, s[4:7], s59 offen
    v_mfma_f32_16x16x32_bf16 v[220:223], v[20:23], a[44:47], v[220:223]
    v_mfma_f32_16x16x32_bf16 v[224:227], v[16:19], a[32:35], v[224:227]
    v_perm_b32 v20, v103, v99, s58
    v_perm_b32 v21, v111, v107, s58
    v_mfma_f32_16x16x32_bf16 v[228:231], v[16:19], a[36:39], v[228:231]
    v_perm_b32 v22, v119, v115, s58
    v_perm_b32 v23, v127, v123, s58
    v_mfma_f32_16x16x32_bf16 v[232:235], v[16:19], a[40:43], v[232:235]
    buffer_load_dwordx4 v[88:91], v30, s[4:7], s59 offen
    v_mfma_f32_16x16x32_bf16 v[236:239], v[16:19], a[44:47], v[236:239]
    s_waitcnt vmcnt(7)
    v_mfma_f32_16x16x32_bf16 v[240:243], v[20:23], a[32:35], v[240:243]
    v_perm_b32 v16, v36, v32, s57
    v_perm_b32 v17, v44, v40, s57
    v_mfma_f32_16x16x32_bf16 v[244:247], v[20:23], a[36:39], v[244:247]
    v_perm_b32 v18, v52, v48, s57
    v_perm_b32 v19, v60, v56, s57
    v_mfma_f32_16x16x32_bf16 v[248:251], v[20:23], a[40:43], v[248:251]
    buffer_load_dwordx4 v[92:95], v31, s[4:7], s59 offen
    v_mfma_f32_16x16x32_bf16 v[252:255], v[20:23], a[44:47], v[252:255]
    s_add_u32 s59, s59, s60
    s_waitcnt lgkmcnt(0)
    v_mfma_f32_16x16x32_bf16 v[128:131], v[16:19], a[0:3], v[128:131]
    v_perm_b32 v20, v36, v32, s58
    v_perm_b32 v21, v44, v40, s58
    v_mfma_f32_16x16x32_bf16 v[132:135], v[16:19], a[4:7], v[132:135]
    v_perm_b32 v22, v52, v48, s58
    v_perm_b32 v23, v60, v56, s58
    v_mfma_f32_16x16x32_bf16 v[136:139], v[16:19], a[8:11], v[136:139]
    buffer_load_dwordx4 v[96:99], v24, s[4:7], s59 offen
    v_mfma_f32_16x16x32_bf16 v[140:143], v[16:19], a[12:15], v[140:143]
    ds_read_b128 a[16:19], v7 offset:256
    v_mfma_f32_16x16x32_bf16 v[144:147], v[20:23], a[0:3], v[144:147]
    v_perm_b32 v16, v37, v33, s57
    v_perm_b32 v17, v45, v41, s57
    v_mfma_f32_16x16x32_bf16 v[148:151], v[20:23], a[4:7], v[148:151]
    v_perm_b32 v18, v53, v49, s57
    v_perm_b32 v19, v61, v57, s57
    v_mfma_f32_16x16x32_bf16 v[152:155], v[20:23], a[8:11], v[152:155]
    buffer_load_dwordx4 v[100:103], v25, s[4:7], s59 offen
    v_mfma_f32_16x16x32_bf16 v[156:159], v[20:23], a[12:15], v[156:159]
    ds_read_b128 a[20:23], v7 offset:16896
    v_mfma_f32_16x16x32_bf16 v[160:163], v[16:19], a[0:3], v[160:163]
    v_perm_b32 v20, v37, v33, s58
    v_perm_b32 v21, v45, v41, s58
    v_mfma_f32_16x16x32_bf16 v[164:167], v[16:19], a[4:7], v[164:167]
    v_perm_b32 v22, v53, v49, s58
    v_perm_b32 v23, v61, v57, s58
    v_mfma_f32_16x16x32_bf16 v[168:171], v[16:19], a[8:11], v[168:171]
    buffer_load_dwordx4 v[104:107], v26, s[4:7], s59 offen
    v_mfma_f32_16x16x32_bf16 v[172:175], v[16:19], a[12:15], v[172:175]
    ds_read_b128 a[24:27], v7 offset:33536
    v_mfma_f32_16x16x32_bf16 v[176:179], v[20:23], a[0:3], v[176:179]
    v_perm_b32 v16, v38, v34, s57
    v_perm_b32 v17, v46, v42, s57
    v_mfma_f32_16x16x32_bf16 v[180:183], v[20:23], a[4:7], v[180:183]
    v_perm_b32 v18, v54, v50, s57
    v_perm_b32 v19, v62, v58, s57
    v_mfma_f32_16x16x32_bf16 v[184:187], v[20:23], a[8:11], v[184:187]
    buffer_load_dwordx4 v[108:111], v27, s[4:7], s59 offen
    v_mfma_f32_16x16x32_bf16 v[188:191], v[20:23], a[12:15], v[188:191]
    ds_read_b128 a[28:31], v7 offset:50176
    v_mfma_f32_16x16x32_bf16 v[192:195], v[16:19], a[0:3], v[192:195]
    v_perm_b32 v20, v38, v34, s58
    v_perm_b32 v21, v46, v42, s58
    v_mfma_f32_16x16x32_bf16 v[196:199], v[16:19], a[4:7], v[196:199]
    v_perm_b32 v22, v54, v50, s58
    v_perm_b32 v23, v62, v58, s58
    v_mfma_f32_16x16x32_bf16 v[200:203], v[16:19], a[8:11], v[200:203]
    buffer_load_dwordx4 v[112:115], v28, s[4:7], s59 offen
    v_mfma_f32_16x16x32_bf16 v[204:207], v[16:19], a[12:15], v[204:207]
    v_mfma_f32_16x16x32_bf16 v[208:211], v[20:23], a[0:3], v[208:211]
    v_perm_b32 v16, v39, v35, s57
    v_perm_b32 v17, v47, v43, s57
    v_mfma_f32_16x16x32_bf16 v[212:215], v[20:23], a[4:7], v[212:215]
    v_perm_b32 v18, v55, v51, s57
    v_perm_b32 v19, v63, v59, s57
    v_mfma_f32_16x16x32_bf16 v[216:219], v[20:23], a[8:11], v[216:219]
    buffer_load_dwordx4 v[116:119], v29, s[4:7], s59 offen
    v_mfma_f32_16x16x32_bf16 v[220:223], v[20:23], a[12:15], v[220:223]
    v_mfma_f32_16x16x32_bf16 v[224:227], v[16:19], a[0:3], v[224:227]
    v_perm_b32 v20, v39, v35, s58
    v_perm_b32 v21, v47, v43, s58
    v_mfma_f32_16x16x32_bf16 v[228:231], v[16:19], a[4:7], v[228:231]
    v_perm_b32 v22, v55, v51, s58
    v_perm_b32 v23, v63, v59, s58
    v_mfma_f32_16x16x32_bf16 v[232:235], v[16:19], a[8:11], v[232:235]
    buffer_load_dwordx4 v[120:123], v30, s[4:7], s59 offen
    v_mfma_f32_16x16x32_bf16 v[236:239], v[16:19], a[12:15], v[236:239]
    s_waitcnt vmcnt(7)
    v_mfma_f32_16x16x32_bf16 v[240:243], v[20:23], a[0:3], v[240:243]
    v_perm_b32 v16, v68, v64, s57
    v_perm_b32 v17, v76, v72, s57
    v_mfma_f32_16x16x32_bf16 v[244:247], v[20:23], a[4:7], v[244:247]
    v_perm_b32 v18, v84, v80, s57
    v_perm_b32 v19, v92, v88, s57
    v_mfma_f32_16x16x32_bf16 v[248:251], v[20:23], a[8:11], v[248:251]
    buffer_load_dwordx4 v[124:127], v31, s[4:7], s59 offen
    v_mfma_f32_16x16x32_bf16 v[252:255], v[20:23], a[12:15], v[252:255]
    s_add_u32 s59, s59, s60
    s_waitcnt lgkmcnt(0)
    v_add_u32 v7, 192, v7
    s_add_u32 s61, s61, 1
    s_cmp_lt_u32 s61, 4
    s_cbranch_scc1 L_gq
    v_mfma_f32_16x16x32_bf16 v[128:131], v[16:19], a[16:19], v[128:131]
    v_perm_b32 v20, v68, v64, s58
    v_perm_b32 v21, v76, v72, s58
    v_mfma_f32_16x16x32_bf16 v[132:135], v[16:19], a[20:23], v[132:135]
    v_perm_b32 v22, v84, v80, s58
    v_perm_b32 v23, v92, v88, s58
    v_mfma_f32_16x16x32_bf16 v[136:139], v[16:19], a[24:27], v[136:139]
    buffer_load_dwordx4 v[32:35], v24, s[4:7], s59 offen
    v_mfma_f32_16x16x32_bf16 v[140:143], v[16:19], a[28:31], v[140:143]
    ds_read_b128 a[32:35], v7 offset:128
    v_mfma_f32_16x16x32_bf16 v[144:147], v[20:23], a[16:19], v[144:147]
    v_perm_b32 v16, v69, v65, s57
    v_perm_b32 v17, v77, v73, s57
    v_mfma_f32_16x16x32_bf16 v[148:151], v[20:23], a[20:23], v[148:151]
    v_perm_b32 v18, v85, v81, s57
    v_perm_b32 v19, v93, v89, s57
    v_mfma_f32_16x16x32_bf16 v[152:155], v[20:23], a[24:27], v[152:155]
    buffer_load_dwordx4 v[36:39], v25, s[4:7], s59 offen
    v_mfma_f32_16x16x32_bf16 v[156:159], v[20:23], a[28:31], v[156:159]
    ds_read_b128 a[36:39], v7 offset:16768
    v_mfma_f32_16x16x32_bf16 v[160:163], v[16:19], a[16:19], v[160:163]
    v_perm_b32 v20, v69, v65, s58
    v_perm_b32 v21, v77, v73, s58
    v_mfma_f32_16x16x32_bf16 v[164:167], v[16:19], a[20:23], v[164:167]
    v_perm_b32 v22, v85, v81, s58
    v_perm_b32 v23, v93, v89, s58
    v_mfma_f32_16x16x32_bf16 v[168:171], v[16:19], a[24:27], v[168:171]
    buffer_load_dwordx4 v[40:43], v26, s[4:7], s59 offen
    v_mfma_f32_16x16x32_bf16 v[172:175], v[16:19], a[28:31], v[172:175]
    ds_read_b128 a[40:43], v7 offset:33408
    v_mfma_f32_16x16x32_bf16 v[176:179], v[20:23], a[16:19], v[176:179]
    v_perm_b32 v16, v70, v66, s57
    v_perm_b32 v17, v78, v74, s57
    v_mfma_f32_16x16x32_bf16 v[180:183], v[20:23], a[20:23], v[180:183]
    v_perm_b32 v18, v86, v82, s57
    v_perm_b32 v19, v94, v90, s57
    v_mfma_f32_16x16x32_bf16 v[184:187], v[20:23], a[24:27], v[184:187]
    buffer_load_dwordx4 v[44:47], v27, s[4:7], s59 offen
    v_mfma_f32_16x16x32_bf16 v[188:191], v[20:23], a[28:31], v[188:191]
    ds_read_b128 a[44:47], v7 offset:50048
    v_mfma_f32_16x16x32_bf16 v[192:195], v[16:19], a[16:19], v[192:195]
    v_perm_b32 v20, v70, v66, s58
    v_perm_b32 v21, v78, v74, s58
    v_mfma_f32_16x16x32_bf16 v[196:199], v[16:19], a[20:23], v[196:199]
    v_perm_b32 v22, v86, v82, s58
    v_perm_b32 v23, v94, v90, s58
    v_mfma_f32_16x16x32_bf16 v[200:203], v[16:19], a[24:27], v[200:203]
    buffer_load_dwordx4 v[48:51], v28, s[4:7], s59 offen
    v_mfma_f32_16x16x32_bf16 v[204:207], v[16:19], a[28:31], v[204:207]
    v_mfma_f32_16x16x32_bf16 v[208:211], v[20:23], a[16:19], v[208:211]
    v_perm_b32 v16, v71, v67, s57
    v_perm_b32 v17, v79, v75, s57
    v_mfma_f32_16x16x32_bf16 v[212:215], v[20:23], a[20:23], v[212:215]
    v_perm_b32 v18, v87, v83, s57
    v_perm_b32 v19, v95, v91, s57
    v_mfma_f32_16x16x32_bf16 v[216:219], v[20:23], a[24:27], v[216:219]
    buffer_load_dwordx4 v[52:55], v29, s[4:7], s59 offen
    v_mfma_f32_16x16x32_bf16 v[220:223], v[20:23], a[28:31], v[220:223]
    v_mfma_f32_16x16x32_bf16 v[224:227], v[16:19], a[16:19], v[224:227]
    v_perm_b32 v20, v71, v67, s58
    v_perm_b32 v21, v79, v75, s58
    v_mfma_f32_16x16x32_bf16 v[228:231], v[16:19], a[20:23], v[228:231]
    v_perm_b32 v22, v87, v83, s58
    v_perm_b32 v23, v95, v91, s58
    v_mfma_f32_16x16x32_bf16 v[232:235], v[16:19], a[24:27], v[232:235]
    buffer_load_dwordx4 v[56:59], v30, s[4:7], s59 offen
    v_mfma_f32_16x16x32_bf16 v[236:239], v[16:19], a[28:31], v[236:239]
    s_waitcnt vmcnt(7)
    v_mfma_f32_16x16x32_bf16 v[240:243], v[20:23], a[16:19], v[240:243]
    v_perm_b32 v16, v100, v96, s57
    v_perm_b32 v17, v108, v104, s57
    v_mfma_f32_16x16x32_bf16 v[244:247], v[20:23], a[20:23], v[244:247]
    v_perm_b32 v18, v116, v112, s57
    v_perm_b32 v19, v124, v120, s57
    v_mfma_f32_16x16x32_bf16 v[248:251], v[20:23], a[24:27], v[248:251]
    buffer_load_dwordx4 v[60:63], v31, s[4:7], s59 offen
    v_mfma_f32_16x16x32_bf16 v[252:255], v[20:23], a[28:31], v[252:255]
    s_add_u32 s59, s59, s60
    s_waitcnt lgkmcnt(0)
    s_cmp_eq_u32 s99, 1
    s_cbranch_scc1 L_otail
    v_mfma_f32_16x16x32_bf16 v[128:131], v[16:19], a[32:35], v[128:131]
    v_perm_b32 v20, v100, v96, s58
    v_perm_b32 v21, v108, v104, s58
    v_mfma_f32_16x16x32_bf16 v[132:135], v[16:19], a[36:39], v[132:135]
    v_perm_b32 v22, v116, v112, s58
    v_perm_b32 v23, v124, v120, s58
    v_mfma_f32_16x16x32_bf16 v[136:139], v[16:19], a[40:43], v[136:139]
    s_mov_b32 s64, 0
    s_add_u32 m0, s70, 0
    v_mfma_f32_16x16x32_bf16 v[140:143], v[16:19], a[44:47], v[140:143]
    buffer_load_dwordx4 v5, s[12:15], s64 offen lds
    ds_read_b128 a[0:3], v7 offset:192
    v_mfma_f32_16x16x32_bf16 v[144:147], v[20:23], a[32:35], v[144:147]
    v_perm_b32 v16, v101, v97, s57
    v_perm_b32 v17, v109, v105, s57
    v_mfma_f32_16x16x32_bf16 v[148:151], v[20:23], a[36:39], v[148:151]
    v_perm_b32 v18, v117, v113, s57
    v_perm_b32 v19, v125, v121, s57
    v_mfma_f32_16x16x32_bf16 v[152:155], v[20:23], a[40:43], v[152:155]
    s_add_u32 m0, m0, 16
    v_mfma_f32_16x16x32_bf16 v[156:159], v[20:23], a[44:47], v[156:159]
    buffer_load_dwordx4 v5, s[12:15], s64 offen offset:1024 lds
    ds_read_b128 a[4:7], v7 offset:16832
    v_mfma_f32_16x16x32_bf16 v[160:163], v[16:19], a[32:35], v[160:163]
    v_perm_b32 v20, v101, v97, s58
    v_perm_b32 v21, v109, v105, s58
    v_mfma_f32_16x16x32_bf16 v[164:167], v[16:19], a[36:39], v[164:167]
    v_perm_b32 v22, v117, v113, s58
    v_perm_b32 v23, v125, v121, s58
    v_mfma_f32_16x16x32_bf16 v[168:171], v[16:19], a[40:43], v[168:171]
    s_add_u32 s64, s64, 8192
    s_add_u32 m0, s70, 8320
    v_mfma_f32_16x16x32_bf16 v[172:175], v[16:19], a[44:47], v[172:175]
    buffer_load_dwordx4 v5, s[12:15], s64 offen lds
    ds_read_b128 a[8:11], v7 offset:33472
    v_mfma_f32_16x16x32_bf16 v[176:179], v[20:23], a[32:35], v[176:179]
    v_perm_b32 v16, v102, v98, s57
    v_perm_b32 v17, v110, v106, s57
    v_mfma_f32_16x16x32_bf16 v[180:183], v[20:23], a[36:39], v[180:183]
    v_perm_b32 v18, v118, v114, s57
    v_perm_b32 v19, v126, v122, s57
    v_mfma_f32_16x16x32_bf16 v[184:187], v[20:23], a[40:43], v[184:187]
    s_add_u32 m0, m0, 16
    v_mfma_f32_16x16x32_bf16 v[188:191], v[20:23], a[44:47], v[188:191]
    buffer_load_dwordx4 v5, s[12:15], s64 offen offset:1024 lds
    ds_read_b128 a[12:15], v7 offset:50112
    v_mfma_f32_16x16x32_bf16 v[192:195], v[16:19], a[32:35], v[192:195]
    v_perm_b32 v20, v102, v98, s58
    v_perm_b32 v21, v110, v106, s58
    v_mfma_f32_16x16x32_bf16 v[196:199], v[16:19], a[36:39], v[196:199]
    v_perm_b32 v22, v118, v114, s58
    v_perm_b32 v23, v126, v122, s58
    v_mfma_f32_16x16x32_bf16 v[200:203], v[16:19], a[40:43], v[200:203]
    s_add_u32 s64, s64, 8192
    s_add_u32 m0, s71, 0
    v_mfma_f32_16x16x32_bf16 v[204:207], v[16:19], a[44:47], v[204:207]
    buffer_load_dwordx4 v6, s[16:19], s64 offen lds
    v_mfma_f32_16x16x32_bf16 v[208:211], v[20:23], a[32:35], v[208:211]
    v_perm_b32 v16, v103, v99, s57
    v_perm_b32 v17, v111, v107, s57
    v_mfma_f32_16x16x32_bf16 v[212:215], v[20:23], a[36:39], v[212:215]
    v_perm_b32 v18, v119, v115, s57
    v_perm_b32 v19, v127, v123, s57
    v_mfma_f32_16x16x32_bf16 v[216:219], v[20:23], a[40:43], v[216:219]
    s_add_u32 m0, m0, 1024
    v_mfma_f32_16x16x32_bf16 v[220:223], v[20:23], a[44:47], v[220:223]
    buffer_load_dwordx4 v15, s[16:19], s64 offen lds
    v_mfma_f32_16x16x32_bf16 v[224:227], v[16:19], a[32:35], v[224:227]
    v_perm_b32 v20, v103, v99, s58
    v_perm_b32 v21, v111, v107, s58
    v_mfma_f32_16x16x32_bf16 v[228:231], v[16:19], a[36:39], v[228:231]
    v_perm_b32 v22, v119, v115, s58
    v_perm_b32 v23, v127, v123, s58
    v_mfma_f32_16x16x32_bf16 v[232:235], v[16:19], a[40:43], v[232:235]
    s_add_u32 m0, s70, 16640
    v_mfma_f32_16x16x32_bf16 v[236:239], v[16:19], a[44:47], v[236:239]
    buffer_load_dwordx4 v5, s[12:15], s64 offen lds
    s_waitcnt vmcnt(7)
    v_mfma_f32_16x16x32_bf16 v[240:243], v[20:23], a[32:35], v[240:243]
    v_perm_b32 v16, v36, v32, s57
    v_perm_b32 v17, v44, v40, s57
    v_mfma_f32_16x16x32_bf16 v[244:247], v[20:23], a[36:39], v[244:247]
    v_perm_b32 v18, v52, v48, s57
    v_perm_b32 v19, v60, v56, s57
    v_mfma_f32_16x16x32_bf16 v[248:251], v[20:23], a[40:43], v[248:251]
    s_add_u32 m0, m0, 16
    v_mfma_f32_16x16x32_bf16 v[252:255], v[20:23], a[44:47], v[252:255]
    buffer_load_dwordx4 v5, s[12:15], s64 offen offset:1024 lds
    s_waitcnt lgkmcnt(0)
    v_mfma_f32_16x16x32_bf16 v[128:131], v[16:19], a[0:3], v[128:131]
    v_perm_b32 v20, v36, v32, s58
    v_perm_b32 v21, v44, v40, s58
    v_mfma_f32_16x16x32_bf16 v[132:135], v[16:19], a[4:7], v[132:135]
    v_perm_b32 v22, v52, v48, s58
    v_perm_b32 v23, v60, v56, s58
    v_mfma_f32_16x16x32_bf16 v[136:139], v[16:19], a[8:11], v[136:139]
    s_add_u32 s64, s64, 8192
    s_add_u32 m0, s71, 8384
    v_mfma_f32_16x16x32_bf16 v[140:143], v[16:19], a[12:15], v[140:143]
    buffer_load_dwordx4 v6, s[16:19], s64 offen lds
    v_mfma_f32_16x16x32_bf16 v[144:147], v[20:23], a[0:3], v[144:147]
    v_perm_b32 v16, v37, v33, s57
    v_perm_b32 v17, v45, v41, s57
    v_mfma_f32_16x16x32_bf16 v[148:151], v[20:23], a[4:7], v[148:151]
    v_perm_b32 v18, v53, v49, s57
    v_perm_b32 v19, v61, v57, s57
    v_mfma_f32_16x16x32_bf16 v[152:155], v[20:23], a[8:11], v[152:155]
    s_add_u32 m0, m0, 1024
    v_mfma_f32_16x16x32_bf16 v[156:159], v[20:23], a[12:15], v[156:159]
    buffer_load_dwordx4 v15, s[16:19], s64 offen lds
    v_mfma_f32_16x16x32_bf16 v[160:163], v[16:19], a[0:3], v[160:163]
    v_perm_b32 v20, v37, v33, s58
    v_perm_b32 v21, v45, v41, s58
    v_mfma_f32_16x16x32_bf16 v[164:167], v[16:19], a[4:7], v[164:167]
    v_perm_b32 v22, v53, v49, s58
    v_perm_b32 v23, v61, v57, s58
    v_mfma_f32_16x16x32_bf16 v[168:171], v[16:19], a[8:11], v[168:171]
    s_add_u32 m0, s70, 24960
    v_mfma_f32_16x16x32_bf16 v[172:175], v[16:19], a[12:15], v[172:175]
    buffer_load_dwordx4 v5, s[12:15], s64 offen lds
    v_mfma_f32_16x16x32_bf16 v[176:179], v[20:23], a[0:3], v[176:179]
    v_perm_b32 v16, v38, v34, s57
    v_perm_b32 v17, v46, v42, s57
    v_mfma_f32_16x16x32_bf16 v[180:183], v[20:23], a[4:7], v[180:183]
    v_perm_b32 v18, v54, v50, s57
    v_perm_b32 v19, v62, v58, s57
    v_mfma_f32_16x16x32_bf16 v[184:187], v[20:23], a[8:11], v[184:187]
    s_add_u32 m0, m0, 16
    v_mfma_f32_16x16x32_bf16 v[188:191], v[20:23], a[12:15], v[188:191]
    buffer_load_dwordx4 v5, s[12:15], s64 offen offset:1024 lds
    v_mfma_f32_16x16x32_bf16 v[192:195], v[16:19], a[0:3], v[192:195]
    v_perm_b32 v20, v38, v34, s58
    v_perm_b32 v21, v46, v42, s58
    v_mfma_f32_16x16x32_bf16 v[196:199], v[16:19], a[4:7], v[196:199]
    v_perm_b32 v22, v54, v50, s58
    v_perm_b32 v23, v62, v58, s58
    v_mfma_f32_16x16x32_bf16 v[200:203], v[16:19], a[8:11], v[200:203]
    v_mfma_f32_16x16x32_bf16 v[204:207], v[16:19], a[12:15], v[204:207]
    v_mfma_f32_16x16x32_bf16 v[208:211], v[20:23], a[0:3], v[208:211]
    v_perm_b32 v16, v39, v35, s57
    v_perm_b32 v17, v47, v43, s57
    v_mfma_f32_16x16x32_bf16 v[212:215], v[20:23], a[4:7], v[212:215]
    v_perm_b32 v18, v55, v51, s57
    v_perm_b32 v19, v63, v59, s57
    v_mfma_f32_16x16x32_bf16 v[216:219], v[20:23], a[8:11], v[216:219]
    v_mfma_f32_16x16x32_bf16 v[220:223], v[20:23], a[12:15], v[220:223]
    v_mfma_f32_16x16x32_bf16 v[224:227], v[16:19], a[0:3], v[224:227]
    v_perm_b32 v20, v39, v35, s58
    v_perm_b32 v21, v47, v43, s58
    v_mfma_f32_16x16x32_bf16 v[228:231], v[16:19], a[4:7], v[228:231]
    v_perm_b32 v22, v55, v51, s58
    v_perm_b32 v23, v63, v59, s58
    v_mfma_f32_16x16x32_bf16 v[232:235], v[16:19], a[8:11], v[232:235]
    v_mfma_f32_16x16x32_bf16 v[236:239], v[16:19], a[12:15], v[236:239]
    v_mfma_f32_16x16x32_bf16 v[240:243], v[20:23], a[0:3], v[240:243]
    v_mfma_f32_16x16x32_bf16 v[244:247], v[20:23], a[4:7], v[244:247]
    v_mfma_f32_16x16x32_bf16 v[248:251], v[20:23], a[8:11], v[248:251]
    v_mfma_f32_16x16x32_bf16 v[252:255], v[20:23], a[12:15], v[252:255]
    s_add_u32 s64, s64, 8192
    s_cmp_eq_u32 s54, 0
    s_cselect_b32 s73, s62, 0
    s_cmp_eq_u32 s73, 1
    s_cbranch_scc0 L_nopub
    s_waitcnt lgkmcnt(0)
    v_max_u32 v8, v8, v9
    v_max3_u32 v8, v8, v10, v11
    s_lshl_b32 s73, s53, 2
    v_mov_b32 v9, s73
    s_mov_b64 exec, 1
    buffer_store_dword v8, v9, s[40:43], 0 offen sc0 sc1
    s_cmp_eq_u32 s2, 0
    s_cbranch_scc0 L_nononce
    v_accvgpr_read_b32 v8, a225
    v_add_u32 v8, 1, v8
    v_max_u32 v8, 1, v8
    v_mov_b32 v9, 18896896
    v_mov_b32 v10, 252
    buffer_store_dword v8, v9, s[20:23], 0 offen sc1
    buffer_store_dword v8, v10, s[40:43], 0 offen sc0 sc1
L_nononce:
    s_mov_b64 exec, -1
L_nopub:
    s_cmp_eq_u32 s56, 7
    s_cselect_b32 s30, 0, s30
    s_cselect_b32 s34, 0, s34
    s_cselect_b32 s38, 0, s38
    v_lshlrev_b32 v14, 4, v1
    v_and_b32 v12, 31, v1
    v_lshlrev_b32 v12, 4, v12
    v_lshrrev_b32 v13, 5, v1
    v_mul_u32_u24 v13, 3584, v13
    v_add_u32 v12, v12, v13
    s_lshr_b32 s75, s80, 5
    s_mul_i32 s75, s75, 512
    s_and_b32 s75, s75, 0xffffff80
    s_lshl_b32 s76, s84, 4
    s_lshl_b32 s77, s54, 2
    s_add_u32 s76, s76, s77
    s_mul_i32 s76, s76, 3584
    s_add_u32 s75, s75, s76
    s_add_u32 s76, s75, 7168
    s_lshl_b32 s77, s80, 13
    s_lshl_b32 s78, s54, 11
    s_add_u32 s77, s77, s78
    buffer_load_dwordx4 a[252:255], v12, s[28:31], s75 offen
    buffer_load_dwordx4 a[252:255], v12, s[28:31], s76 offen
    buffer_load_dwordx4 a[252:255], v12, s[32:35], s75 offen
    buffer_load_dwordx4 a[252:255], v12, s[32:35], s76 offen
    buffer_load_dwordx4 a[252:255], v14, s[36:39], s77 offen offset:0
    buffer_load_dwordx4 a[252:255], v14, s[36:39], s77 offen offset:1024
    v_lshlrev_b32 v12, 21, v1
    s_lshl_b32 s75, s53, 16
    v_add_u32 v12, s75, v12
    v_mov_b32 v13, 18898944
    v_cmp_gt_u32 vcc, 8, v1
    s_nop 1
    v_cndmask_b32 v12, v13, v12, vcc
    buffer_load_dword a252, v12, s[20:23], 0 offen sc1
    v_cvt_pk_bf16_f32 v32, v128, v144
    v_cvt_pk_bf16_f32 v33, v160, v176
    v_cvt_pk_bf16_f32 v34, v129, v145
    v_cvt_pk_bf16_f32 v35, v161, v177
    v_cvt_pk_bf16_f32 v36, v130, v146
    v_cvt_pk_bf16_f32 v37, v162, v178
    v_cvt_pk_bf16_f32 v38, v131, v147
    v_cvt_pk_bf16_f32 v39, v163, v179
    v_cvt_pk_bf16_f32 v40, v132, v148
    v_cvt_pk_bf16_f32 v41, v164, v180
    v_cvt_pk_bf16_f32 v42, v133, v149
    v_cvt_pk_bf16_f32 v43, v165, v181
    v_cvt_pk_bf16_f32 v44, v134, v150
    v_cvt_pk_bf16_f32 v45, v166, v182
    v_cvt_pk_bf16_f32 v46, v135, v151
    v_cvt_pk_bf16_f32 v47, v167, v183
    v_cvt_pk_bf16_f32 v48, v136, v152
    v_cvt_pk_bf16_f32 v49, v168, v184
    v_cvt_pk_bf16_f32 v50, v137, v153
    v_cvt_pk_bf16_f32 v51, v169, v185
    v_cvt_pk_bf16_f32 v52, v138, v154
    v_cvt_pk_bf16_f32 v53, v170, v186
    v_cvt_pk_bf16_f32 v54, v139, v155
    v_cvt_pk_bf16_f32 v55, v171, v187
    v_cvt_pk_bf16_f32 v56, v140, v156
    v_cvt_pk_bf16_f32 v57, v172, v188
    v_cvt_pk_bf16_f32 v58, v141, v157
    v_cvt_pk_bf16_f32 v59, v173, v189
    v_cvt_pk_bf16_f32 v60, v142, v158
    v_cvt_pk_bf16_f32 v61, v174, v190
    v_cvt_pk_bf16_f32 v62, v143, v159
    v_cvt_pk_bf16_f32 v63, v175, v191
    v_cvt_pk_bf16_f32 v130, v192, v208
    v_cvt_pk_bf16_f32 v131, v224, v240
    v_cvt_pk_bf16_f32 v134, v193, v209
    v_cvt_pk_bf16_f32 v135, v225, v241
    v_cvt_pk_bf16_f32 v138, v194, v210
    v_cvt_pk_bf16_f32 v139, v226, v242
    v_cvt_pk_bf16_f32 v142, v195, v211
    v_cvt_pk_bf16_f32 v143, v227, v243
    v_cvt_pk_bf16_f32 v146, v196, v212
    v_cvt_pk_bf16_f32 v147, v228, v244
    v_cvt_pk_bf16_f32 v150, v197, v213
    v_cvt_pk_bf16_f32 v151, v229, v245
    v_cvt_pk_bf16_f32 v154, v198, v214
    v_cvt_pk_bf16_f32 v155, v230, v246
    v_cvt_pk_bf16_f32 v158, v199, v215
    v_cvt_pk_bf16_f32 v159, v231, v247
    v_cvt_pk_bf16_f32 v162, v200, v216
    v_cvt_pk_bf16_f32 v163, v232, v248
    v_cvt_pk_bf16_f32 v166, v201, v217
    v_cvt_pk_bf16_f32 v167, v233, v249
    v_cvt_pk_bf16_f32 v170, v202, v218
    v_cvt_pk_bf16_f32 v171, v234, v250
    v_cvt_pk_bf16_f32 v174, v203, v219
    v_cvt_pk_bf16_f32 v175, v235, v251
    v_cvt_pk_bf16_f32 v178, v204, v220
    v_cvt_pk_bf16_f32 v179, v236, v252
    v_cvt_pk_bf16_f32 v182, v205, v221
    v_cvt_pk_bf16_f32 v183, v237, v253
    v_cvt_pk_bf16_f32 v186, v206, v222
    v_cvt_pk_bf16_f32 v187, v238, v254
    v_cvt_pk_bf16_f32 v190, v207, v223
    v_cvt_pk_bf16_f32 v191, v239, v255
    v_mov_b64 v[128:129], v[32:33]
    v_mov_b64 v[132:133], v[34:35]
    v_mov_b64 v[136:137], v[36:37]
    v_mov_b64 v[140:141], v[38:39]
    v_mov_b64 v[144:145], v[40:41]
    v_mov_b64 v[148:149], v[42:43]
    v_mov_b64 v[152:153], v[44:45]
    v_mov_b64 v[156:157], v[46:47]
    v_mov_b64 v[160:161], v[48:49]
    v_mov_b64 v[164:165], v[50:51]
    v_mov_b64 v[168:169], v[52:53]
    v_mov_b64 v[172:173], v[54:55]
    v_mov_b64 v[176:177], v[56:57]
    v_mov_b64 v[180:181], v[58:59]
    v_mov_b64 v[184:185], v[60:61]
    v_mov_b64 v[188:189], v[62:63]
    v_permlane16_swap_b32 v128, v144
    v_permlane16_swap_b32 v129, v145
    v_permlane16_swap_b32 v130, v146
    v_permlane16_swap_b32 v131, v147
    v_permlane16_swap_b32 v132, v148
    v_permlane16_swap_b32 v133, v149
    v_permlane16_swap_b32 v134, v150
    v_permlane16_swap_b32 v135, v151
    v_permlane16_swap_b32 v136, v152
    v_permlane16_swap_b32 v137, v153
    v_permlane16_swap_b32 v138, v154
    v_permlane16_swap_b32 v139, v155
    v_permlane16_swap_b32 v140, v156
    v_permlane16_swap_b32 v141, v157
    v_permlane16_swap_b32 v142, v158
    v_permlane16_swap_b32 v143, v159
    v_permlane16_swap_b32 v160, v176
    v_permlane16_swap_b32 v161, v177
    v_permlane16_swap_b32 v162, v178
    v_permlane16_swap_b32 v163, v179
    v_permlane16_swap_b32 v164, v180
    v_permlane16_swap_b32 v165, v181
    v_permlane16_swap_b32 v166, v182
    v_permlane16_swap_b32 v167, v183
    v_permlane16_swap_b32 v168, v184
    v_permlane16_swap_b32 v169, v185
    v_permlane16_swap_b32 v170, v186
    v_permlane16_swap_b32 v171, v187
    v_permlane16_swap_b32 v172, v188
    v_permlane16_swap_b32 v173, v189
    v_permlane16_swap_b32 v174, v190
    v_permlane16_swap_b32 v175, v191
L_attn:
    v_mov_b32 v8, 0
    v_mov_b32 v9, 0
    s_mov_b32 s68, 4294950656
    s_mov_b32 s69, 16768
    s_mov_b32 s66, s70
    s_add_u32 s67, s71, 16768
    s_waitcnt vmcnt(7)
    s_barrier
    ds_read_b128 a[0:3], v2 offset:0
    ds_read_b128 a[4:7], v2 offset:16
    ds_read_b128 a[8:11], v2 offset:32
    s_waitcnt lgkmcnt(1)
    v_mfma_f32_32x32x16_bf16 v[192:207], a[0:3], v[128:131], 0
    ds_read_b128 a[12:15], v2 offset:48
    v_mfma_f32_32x32x16_bf16 v[208:223], a[0:3], v[160:163], 0
    v_mfma_f32_32x32x16_bf16 v[192:207], a[4:7], v[132:135], v[192:207]
    ds_read_b128 a[0:3], v3 offset:0
    v_mfma_f32_32x32x16_bf16 v[208:223], a[4:7], v[164:167], v[208:223]
    s_waitcnt lgkmcnt(1)
    v_mfma_f32_32x32x16_bf16 v[192:207], a[8:11], v[136:139], v[192:207]
    ds_read_b128 a[4:7], v3 offset:16
    v_mfma_f32_32x32x16_bf16 v[208:223], a[8:11], v[168:171], v[208:223]
    v_mfma_f32_32x32x16_bf16 v[192:207], a[12:15], v[140:143], v[192:207]
    ds_read_b128 a[8:11], v3 offset:32
    v_mfma_f32_32x32x16_bf16 v[208:223], a[12:15], v[172:175], v[208:223]
    s_waitcnt lgkmcnt(1)
    v_mfma_f32_32x32x16_bf16 v[192:207], a[0:3], v[144:147], v[192:207]
    ds_read_b128 a[12:15], v3 offset:48
    v_mfma_f32_32x32x16_bf16 v[208:223], a[0:3], v[176:179], v[208:223]
    v_mfma_f32_32x32x16_bf16 v[192:207], a[4:7], v[148:151], v[192:207]
    ds_read_b128 a[0:3], v2 offset:8320
    v_mfma_f32_32x32x16_bf16 v[208:223], a[4:7], v[180:183], v[208:223]
    s_waitcnt lgkmcnt(1)
    v_mfma_f32_32x32x16_bf16 v[192:207], a[8:11], v[152:155], v[192:207]
    ds_read_b128 a[4:7], v2 offset:8336
    v_mfma_f32_32x32x16_bf16 v[208:223], a[8:11], v[184:187], v[208:223]
    v_mfma_f32_32x32x16_bf16 v[192:207], a[12:15], v[156:159], v[192:207]
    ds_read_b128 a[8:11], v2 offset:8352
    v_mfma_f32_32x32x16_bf16 v[208:223], a[12:15], v[188:191], v[208:223]
    s_waitcnt lgkmcnt(1)
    s_nop 8
    v_max3_f32 v10, v192, v193, v194
    v_max3_f32 v10, v10, v195, v196
    v_max3_f32 v10, v10, v197, v198
    v_max3_f32 v10, v10, v199, v200
    v_max3_f32 v10, v10, v201, v202
    v_max3_f32 v10, v10, v203, v204
    v_max3_f32 v10, v10, v205, v206
    v_accvgpr_read_b32 v12, a221
    v_max3_f32 v10, v10, v207, v12
    v_mov_b32 v12, v10
    v_max3_f32 v11, v208, v209, v210
    v_max3_f32 v11, v11, v211, v212
    v_max3_f32 v11, v11, v213, v214
    v_max3_f32 v11, v11, v215, v216
    v_max3_f32 v11, v11, v217, v218
    v_max3_f32 v11, v11, v219, v220
    v_max3_f32 v11, v11, v221, v222
    v_accvgpr_read_b32 v13, a222
    v_max3_f32 v11, v11, v223, v13
    v_mov_b32 v13, v11
    v_permlane32_swap_b32 v10, v12
    v_max_f32 v10, v10, v12
    v_sub_f32 v96, 0, v10
    v_sub_f32 v97, 0, v10
    v_permlane32_swap_b32 v11, v13
    v_max_f32 v11, v11, v13
    v_sub_f32 v112, 0, v11
    v_sub_f32 v113, 0, v11
    v_mov_b64 v[98:99], v[96:97]
    v_mov_b64 v[100:101], v[96:97]
    v_mov_b64 v[102:103], v[96:97]
    v_mov_b64 v[104:105], v[96:97]
    v_mov_b64 v[106:107], v[96:97]
    v_mov_b64 v[108:109], v[96:97]
    v_mov_b64 v[110:111], v[96:97]
    v_pk_add_f32 v[192:193], v[192:193], v[96:97]
    v_pk_add_f32 v[194:195], v[194:195], v[96:97]
    v_pk_add_f32 v[196:197], v[196:197], v[96:97]
    v_pk_add_f32 v[198:199], v[198:199], v[96:97]
    v_pk_add_f32 v[200:201], v[200:201], v[96:97]
    v_pk_add_f32 v[202:203], v[202:203], v[96:97]
    v_pk_add_f32 v[204:205], v[204:205], v[96:97]
    v_pk_add_f32 v[206:207], v[206:207], v[96:97]
    v_mov_b64 v[114:115], v[112:113]
    v_mov_b64 v[116:117], v[112:113]
    v_mov_b64 v[118:119], v[112:113]
    v_mov_b64 v[120:121], v[112:113]
    v_mov_b64 v[122:123], v[112:113]
    v_mov_b64 v[124:125], v[112:113]
    v_mov_b64 v[126:127], v[112:113]
    v_pk_add_f32 v[208:209], v[208:209], v[112:113]
    v_pk_add_f32 v[210:211], v[210:211], v[112:113]
    v_pk_add_f32 v[212:213], v[212:213], v[112:113]
    v_pk_add_f32 v[214:215], v[214:215], v[112:113]
    v_pk_add_f32 v[216:217], v[216:217], v[112:113]
    v_pk_add_f32 v[218:219], v[218:219], v[112:113]
    v_pk_add_f32 v[220:221], v[220:221], v[112:113]
    v_pk_add_f32 v[222:223], v[222:223], v[112:113]
    v_mfma_f32_32x32x16_bf16 v[224:239], a[0:3], v[128:131], v[96:111]
    ds_read_b128 a[12:15], v2 offset:8368
    v_exp_f32 v192, v192
    v_exp_f32 v193, v193
    v_exp_f32 v194, v194
    v_mfma_f32_32x32x16_bf16 v[240:255], a[0:3], v[160:163], v[112:127]
    v_cvt_pk_bf16_f32 v16, v192, v193
    v_exp_f32 v195, v195
    v_exp_f32 v196, v196
    v_exp_f32 v197, v197
    s_barrier
    v_mfma_f32_32x32x16_bf16 v[224:239], a[4:7], v[132:135], v[224:239]
    ds_read_b128 a[0:3], v3 offset:8320
    v_exp_f32 v198, v198
    v_exp_f32 v199, v199
    v_exp_f32 v208, v208
    s_add_u32 m0, s70, 0
    v_mfma_f32_32x32x16_bf16 v[240:255], a[4:7], v[164:167], v[240:255]
    buffer_load_dwordx4 v5, s[12:15], s64 offen lds
    v_exp_f32 v209, v209
    v_exp_f32 v210, v210
    v_exp_f32 v211, v211
    s_waitcnt lgkmcnt(1)
    v_mfma_f32_32x32x16_bf16 v[224:239], a[8:11], v[136:139], v[224:239]
    ds_read_b128 a[4:7], v3 offset:8336
    v_cvt_pk_bf16_f32 v17, v194, v195
    v_exp_f32 v212, v212
    v_exp_f32 v213, v213
    v_exp_f32 v214, v214
    v_mfma_f32_32x32x16_bf16 v[240:255], a[8:11], v[168:171], v[240:255]
    v_cvt_pk_bf16_f32 v18, v196, v197
    v_exp_f32 v215, v215
    v_exp_f32 v200, v200
    v_exp_f32 v201, v201
    s_add_u32 m0, m0, 16
    v_mfma_f32_32x32x16_bf16 v[224:239], a[12:15], v[140:143], v[224:239]
    ds_read_b128 a[8:11], v3 offset:8352
    buffer_load_dwordx4 v5, s[12:15], s64 offen offset:1024 lds
    v_exp_f32 v202, v202
    v_exp_f32 v203, v203
    v_exp_f32 v204, v204
    v_mfma_f32_32x32x16_bf16 v[240:255], a[12:15], v[172:175], v[240:255]
    v_cvt_pk_bf16_f32 v19, v198, v199
    v_exp_f32 v205, v205
    v_exp_f32 v206, v206
    v_exp_f32 v207, v207
    s_waitcnt lgkmcnt(1)
    v_mfma_f32_32x32x16_bf16 v[224:239], a[0:3], v[144:147], v[224:239]
    ds_read_b128 a[12:15], v3 offset:8368
    v_cvt_pk_bf16_f32 v24, v208, v209
    v_cvt_pk_bf16_f32 v25, v210, v211
    v_exp_f32 v216, v216
    v_exp_f32 v217, v217
    s_add_u32 m0, s71, 16768
    v_mfma_f32_32x32x16_bf16 v[240:255], a[0:3], v[176:179], v[240:255]
    buffer_load_dwordx4 v6, s[16:19], s64 offen lds
    v_cvt_pk_bf16_f32 v26, v212, v213
    v_cvt_pk_bf16_f32 v27, v214, v215
    v_cvt_pk_bf16_f32 v20, v200, v201
    v_cvt_pk_bf16_f32 v21, v202, v203
    v_cvt_pk_bf16_f32 v22, v204, v205
    v_exp_f32 v218, v218
    v_mfma_f32_32x32x16_bf16 v[224:239], a[4:7], v[148:151], v[224:239]
    ds_read_b64_tr_b16 a[0:1], v4 offset:0
    v_cvt_pk_bf16_f32 v23, v206, v207
    v_cvt_pk_bf16_f32 v28, v216, v217
    v_add_f32 v8, v8, v192
    v_add_f32 v8, v8, v193
    v_add_f32 v8, v8, v194
    v_exp_f32 v219, v219
    v_mfma_f32_32x32x16_bf16 v[240:255], a[4:7], v[180:183], v[240:255]
    ds_read_b64_tr_b16 a[2:3], v4 offset:512
    v_cvt_pk_bf16_f32 v29, v218, v219
    v_add_f32 v8, v8, v195
    v_add_f32 v8, v8, v196
    v_exp_f32 v220, v220
    s_waitcnt lgkmcnt(2)
    s_add_u32 m0, m0, 1024
    v_mfma_f32_32x32x16_bf16 v[224:239], a[8:11], v[152:155], v[224:239]
    ds_read_b64_tr_b16 a[4:5], v4 offset:64
    buffer_load_dwordx4 v15, s[16:19], s64 offen lds
    v_add_f32 v8, v8, v197
    v_add_f32 v8, v8, v198
    v_add_f32 v8, v8, v199
    v_exp_f32 v221, v221
    s_mul_i32 s74, s54, 8192
    v_mfma_f32_32x32x16_bf16 v[240:255], a[8:11], v[184:187], v[240:255]
    ds_read_b64_tr_b16 a[6:7], v4 offset:576
    v_cvt_pk_bf16_f32 v30, v220, v221
    v_add_f32 v9, v9, v208
    v_add_f32 v9, v9, v209
    v_add_f32 v9, v9, v210
    v_exp_f32 v222, v222
    s_add_u32 s64, s64, 8192
    v_mfma_f32_32x32x16_bf16 v[224:239], a[12:15], v[156:159], v[224:239]
    ds_read_b64_tr_b16 a[8:9], v4 offset:128
    v_add_f32 v9, v9, v211
    v_add_f32 v9, v9, v212
    v_add_f32 v9, v9, v213
    v_exp_f32 v223, v223
    v_lshlrev_b32 v14, 4, v1
    s_mul_i32 s73, s83, 32768
    v_mfma_f32_32x32x16_bf16 v[240:255], a[12:15], v[188:191], v[240:255]
    ds_read_b64_tr_b16 a[10:11], v4 offset:640
    v_cvt_pk_bf16_f32 v31, v222, v223
    v_add_f32 v9, v9, v214
    s_waitcnt lgkmcnt(2)
    v_add_u32 v2, 16640, v2
    v_add_u32 v3, 16640, v3
    s_mov_b32 s61, 0
    s_add_u32 s73, s73, s74
    v_add_f32 v9, v9, v215
    v_add_f32 v8, v8, v200
    v_add_f32 v8, v8, v201
    v_add_f32 v8, v8, v202
    v_add_f32 v8, v8, v203
    v_add_f32 v8, v8, v204
    v_add_f32 v8, v8, v205
    v_add_f32 v8, v8, v206
    v_add_f32 v8, v8, v207
    v_add_f32 v9, v9, v216
    v_add_f32 v9, v9, v217
    v_add_f32 v9, v9, v218
    v_add_f32 v9, v9, v219
    v_add_f32 v9, v9, v220
    v_add_f32 v9, v9, v221
    v_add_f32 v9, v9, v222
    v_add_f32 v9, v9, v223
L_al:
    v_mfma_f32_32x32x16_bf16 a[64:79], a[0:3], v[16:19], a[64:79]
    ds_read_b64_tr_b16 a[12:13], v4 offset:192
    v_mfma_f32_32x32x16_bf16 a[128:143], a[0:3], v[24:27], a[128:143]
    ds_read_b64_tr_b16 a[14:15], v4 offset:704
    v_mfma_f32_32x32x16_bf16 a[80:95], a[4:7], v[16:19], a[80:95]
    ds_read_b64_tr_b16 a[0:1], v4 offset:1024
    v_mfma_f32_32x32x16_bf16 a[144:159], a[4:7], v[24:27], a[144:159]
    ds_read_b64_tr_b16 a[2:3], v4 offset:1536
    v_exp_f32 v224, v224
    v_exp_f32 v225, v225
    s_waitcnt lgkmcnt(2)
    v_mfma_f32_32x32x16_bf16 a[96:111], a[8:11], v[16:19], a[96:111]
    ds_read_b64_tr_b16 a[4:5], v4 offset:1088
    v_add_f32 v8, v8, v224
    v_exp_f32 v226, v226
    v_exp_f32 v227, v227
    v_mfma_f32_32x32x16_bf16 a[160:175], a[8:11], v[24:27], a[160:175]
    ds_read_b64_tr_b16 a[6:7], v4 offset:1600
    v_add_f32 v8, v8, v225
    v_exp_f32 v228, v228
    v_exp_f32 v229, v229
    v_mfma_f32_32x32x16_bf16 a[112:127], a[12:15], v[16:19], a[112:127]
    ds_read_b64_tr_b16 a[8:9], v4 offset:1152
    v_add_f32 v8, v8, v226
    v_add_f32 v8, v8, v227
    v_add_f32 v8, v8, v228
    v_exp_f32 v230, v230
    v_mfma_f32_32x32x16_bf16 a[176:191], a[12:15], v[24:27], a[176:191]
    ds_read_b64_tr_b16 a[10:11], v4 offset:1664
    v_cvt_pk_bf16_f32 v16, v224, v225
    v_cvt_pk_bf16_f32 v17, v226, v227
    v_exp_f32 v231, v231
    s_waitcnt lgkmcnt(2)
    v_mfma_f32_32x32x16_bf16 a[64:79], a[0:3], v[20:23], a[64:79]
    ds_read_b64_tr_b16 a[12:13], v4 offset:1216
    v_cvt_pk_bf16_f32 v18, v228, v229
    v_cvt_pk_bf16_f32 v19, v230, v231
    v_add_f32 v8, v8, v229
    v_exp_f32 v240, v240
    v_mfma_f32_32x32x16_bf16 a[128:143], a[0:3], v[28:31], a[128:143]
    ds_read_b64_tr_b16 a[14:15], v4 offset:1728
    v_add_f32 v8, v8, v230
    v_exp_f32 v241, v241
    s_waitcnt vmcnt(6)
    s_barrier
    v_mfma_f32_32x32x16_bf16 a[80:95], a[4:7], v[20:23], a[80:95]
    ds_read_b128 a[0:3], v2 offset:0
    v_cvt_pk_bf16_f32 v24, v240, v241
    v_add_f32 v8, v8, v231
    v_exp_f32 v242, v242
    s_add_u32 m0, s66, 8320
    v_mfma_f32_32x32x16_bf16 a[144:159], a[4:7], v[28:31], a[144:159]
    buffer_load_dwordx4 v5, s[12:15], s64 offen lds
    v_add_f32 v9, v9, v240
    v_add_f32 v9, v9, v241
    v_exp_f32 v243, v243
    s_waitcnt lgkmcnt(1)
    v_mfma_f32_32x32x16_bf16 a[96:111], a[8:11], v[20:23], a[96:111]
    ds_read_b128 a[4:7], v2 offset:16
    v_cvt_pk_bf16_f32 v25, v242, v243
    v_add_f32 v9, v9, v242
    v_exp_f32 v244, v244
    s_add_u32 m0, m0, 16
    v_mfma_f32_32x32x16_bf16 a[160:175], a[8:11], v[28:31], a[160:175]
    buffer_load_dwordx4 v5, s[12:15], s64 offen offset:1024 lds
    v_add_f32 v9, v9, v243
    v_add_f32 v9, v9, v244
    v_exp_f32 v245, v245
    v_mfma_f32_32x32x16_bf16 a[112:127], a[12:15], v[20:23], a[112:127]
    ds_read_b128 a[8:11], v2 offset:32
    v_cvt_pk_bf16_f32 v26, v244, v245
    v_add_f32 v9, v9, v245
    v_exp_f32 v246, v246
    s_add_u32 m0, s67, 8384
    v_mfma_f32_32x32x16_bf16 a[176:191], a[12:15], v[28:31], a[176:191]
    buffer_load_dwordx4 v6, s[16:19], s64 offen lds
    v_add_f32 v9, v9, v246
    v_exp_f32 v247, v247
    s_waitcnt lgkmcnt(1)
    v_mfma_f32_32x32x16_bf16 v[192:207], a[0:3], v[128:131], v[96:111]
    ds_read_b128 a[12:15], v2 offset:48
    v_cvt_pk_bf16_f32 v27, v246, v247
    v_add_f32 v9, v9, v247
    v_exp_f32 v232, v232
    s_add_u32 m0, m0, 1024
    v_mfma_f32_32x32x16_bf16 v[208:223], a[0:3], v[160:163], v[112:127]
    buffer_load_dwordx4 v15, s[16:19], s64 offen lds
    v_add_f32 v8, v8, v232
    v_exp_f32 v233, v233
    v_mfma_f32_32x32x16_bf16 v[192:207], a[4:7], v[132:135], v[192:207]
    ds_read_b128 a[0:3], v3 offset:0
    v_cvt_pk_bf16_f32 v20, v232, v233
    v_add_f32 v8, v8, v233
    v_exp_f32 v234, v234
    v_mfma_f32_32x32x16_bf16 v[208:223], a[4:7], v[164:167], v[208:223]
    v_add_f32 v8, v8, v234
    v_exp_f32 v235, v235
    s_waitcnt lgkmcnt(1)
    s_add_u32 s64, s64, 8192
    v_mfma_f32_32x32x16_bf16 v[192:207], a[8:11], v[136:139], v[192:207]
    ds_read_b128 a[4:7], v3 offset:16
    v_cvt_pk_bf16_f32 v21, v234, v235
    v_add_f32 v8, v8, v235
    v_exp_f32 v236, v236
    v_mfma_f32_32x32x16_bf16 v[208:223], a[8:11], v[168:171], v[208:223]
    v_add_f32 v8, v8, v236
    v_exp_f32 v237, v237
    s_sub_u32 s66, s66, s68
    v_mfma_f32_32x32x16_bf16 v[192:207], a[12:15], v[140:143], v[192:207]
    ds_read_b128 a[8:11], v3 offset:32
    v_cvt_pk_bf16_f32 v22, v236, v237
    v_add_f32 v8, v8, v237
    v_exp_f32 v238, v238
    v_mfma_f32_32x32x16_bf16 v[208:223], a[12:15], v[172:175], v[208:223]
    v_add_f32 v8, v8, v238
    v_exp_f32 v239, v239
    s_waitcnt lgkmcnt(1)
    s_sub_u32 s67, s67, s69
    v_mfma_f32_32x32x16_bf16 v[192:207], a[0:3], v[144:147], v[192:207]
    ds_read_b128 a[12:15], v3 offset:48
    v_cvt_pk_bf16_f32 v23, v238, v239
    v_add_f32 v8, v8, v239
    v_exp_f32 v248, v248
    v_mfma_f32_32x32x16_bf16 v[208:223], a[0:3], v[176:179], v[208:223]
    v_add_f32 v9, v9, v248
    v_exp_f32 v249, v249
    buffer_load_dwordx4 a[252:255], v14, s[44:47], s73 offen
    v_mfma_f32_32x32x16_bf16 v[192:207], a[4:7], v[148:151], v[192:207]
    ds_read_b64_tr_b16 a[0:1], v4 offset:8384
    v_cvt_pk_bf16_f32 v28, v248, v249
    v_add_f32 v9, v9, v249
    v_exp_f32 v250, v250
    v_mfma_f32_32x32x16_bf16 v[208:223], a[4:7], v[180:183], v[208:223]
    ds_read_b64_tr_b16 a[2:3], v4 offset:8896
    v_add_f32 v9, v9, v250
    v_exp_f32 v251, v251
    s_waitcnt lgkmcnt(2)
    s_add_u32 s73, s73, 1024
    v_mfma_f32_32x32x16_bf16 v[192:207], a[8:11], v[152:155], v[192:207]
    ds_read_b64_tr_b16 a[4:5], v4 offset:8448
    v_cvt_pk_bf16_f32 v29, v250, v251
    v_add_f32 v9, v9, v251
    v_exp_f32 v252, v252
    v_mfma_f32_32x32x16_bf16 v[208:223], a[8:11], v[184:187], v[208:223]
    ds_read_b64_tr_b16 a[6:7], v4 offset:8960
    v_add_f32 v9, v9, v252
    v_exp_f32 v253, v253
    v_mfma_f32_32x32x16_bf16 v[192:207], a[12:15], v[156:159], v[192:207]
    ds_read_b64_tr_b16 a[8:9], v4 offset:8512
    v_cvt_pk_bf16_f32 v30, v252, v253
    v_add_f32 v9, v9, v253
    v_exp_f32 v254, v254
    v_mfma_f32_32x32x16_bf16 v[208:223], a[12:15], v[188:191], v[208:223]
    ds_read_b64_tr_b16 a[10:11], v4 offset:9024
    v_add_f32 v9, v9, v254
    v_exp_f32 v255, v255
    s_waitcnt lgkmcnt(2)
    v_cvt_pk_bf16_f32 v31, v254, v255
    v_add_f32 v9, v9, v255
    v_mfma_f32_32x32x16_bf16 a[64:79], a[0:3], v[16:19], a[64:79]
    ds_read_b64_tr_b16 a[12:13], v4 offset:8576
    v_mfma_f32_32x32x16_bf16 a[128:143], a[0:3], v[24:27], a[128:143]
    ds_read_b64_tr_b16 a[14:15], v4 offset:9088
    v_mfma_f32_32x32x16_bf16 a[80:95], a[4:7], v[16:19], a[80:95]
    ds_read_b64_tr_b16 a[0:1], v4 offset:9408
    v_mfma_f32_32x32x16_bf16 a[144:159], a[4:7], v[24:27], a[144:159]
    ds_read_b64_tr_b16 a[2:3], v4 offset:9920
    v_exp_f32 v192, v192
    v_exp_f32 v193, v193
    s_waitcnt lgkmcnt(2)
    v_mfma_f32_32x32x16_bf16 a[96:111], a[8:11], v[16:19], a[96:111]
    ds_read_b64_tr_b16 a[4:5], v4 offset:9472
    v_add_f32 v8, v8, v192
    v_exp_f32 v194, v194
    v_exp_f32 v195, v195
    v_mfma_f32_32x32x16_bf16 a[160:175], a[8:11], v[24:27], a[160:175]
    ds_read_b64_tr_b16 a[6:7], v4 offset:9984
    v_add_f32 v8, v8, v193
    v_exp_f32 v196, v196
    v_exp_f32 v197, v197
    v_mfma_f32_32x32x16_bf16 a[112:127], a[12:15], v[16:19], a[112:127]
    ds_read_b64_tr_b16 a[8:9], v4 offset:9536
    v_add_f32 v8, v8, v194
    v_add_f32 v8, v8, v195
    v_add_f32 v8, v8, v196
    v_exp_f32 v198, v198
    v_mfma_f32_32x32x16_bf16 a[176:191], a[12:15], v[24:27], a[176:191]
    ds_read_b64_tr_b16 a[10:11], v4 offset:10048
    v_cvt_pk_bf16_f32 v16, v192, v193
    v_cvt_pk_bf16_f32 v17, v194, v195
    v_exp_f32 v199, v199
    s_waitcnt lgkmcnt(2)
    v_mfma_f32_32x32x16_bf16 a[64:79], a[0:3], v[20:23], a[64:79]
    ds_read_b64_tr_b16 a[12:13], v4 offset:9600
    v_cvt_pk_bf16_f32 v18, v196, v197
    v_cvt_pk_bf16_f32 v19, v198, v199
    v_add_f32 v8, v8, v197
    v_exp_f32 v208, v208
    v_mfma_f32_32x32x16_bf16 a[128:143], a[0:3], v[28:31], a[128:143]
    ds_read_b64_tr_b16 a[14:15], v4 offset:10112
    v_add_f32 v8, v8, v198
    v_exp_f32 v209, v209
    s_waitcnt vmcnt(5)
    s_barrier
    v_mfma_f32_32x32x16_bf16 a[80:95], a[4:7], v[20:23], a[80:95]
    ds_read_b128 a[0:3], v2 offset:8320
    v_cvt_pk_bf16_f32 v24, v208, v209
    v_add_f32 v8, v8, v199
    v_exp_f32 v210, v210
    s_add_u32 m0, s66, 0
    v_mfma_f32_32x32x16_bf16 a[144:159], a[4:7], v[28:31], a[144:159]
    buffer_load_dwordx4 v5, s[12:15], s64 offen lds
    v_add_f32 v9, v9, v208
    v_add_f32 v9, v9, v209
    v_exp_f32 v211, v211
    s_waitcnt lgkmcnt(1)
    v_mfma_f32_32x32x16_bf16 a[96:111], a[8:11], v[20:23], a[96:111]
    ds_read_b128 a[4:7], v2 offset:8336
    v_cvt_pk_bf16_f32 v25, v210, v211
    v_add_f32 v9, v9, v210
    v_exp_f32 v212, v212
    s_add_u32 m0, m0, 16
    v_mfma_f32_32x32x16_bf16 a[160:175], a[8:11], v[28:31], a[160:175]
    buffer_load_dwordx4 v5, s[12:15], s64 offen offset:1024 lds
    v_add_f32 v9, v9, v211
    v_add_f32 v9, v9, v212
    v_exp_f32 v213, v213
    v_mfma_f32_32x32x16_bf16 a[112:127], a[12:15], v[20:23], a[112:127]
    ds_read_b128 a[8:11], v2 offset:8352
    v_cvt_pk_bf16_f32 v26, v212, v213
    v_add_f32 v9, v9, v213
    v_exp_f32 v214, v214
    s_add_u32 m0, s67, 0
    v_mfma_f32_32x32x16_bf16 a[176:191], a[12:15], v[28:31], a[176:191]
    buffer_load_dwordx4 v6, s[16:19], s64 offen lds
    v_add_f32 v9, v9, v214
    v_exp_f32 v215, v215
    s_waitcnt lgkmcnt(1)
    v_mfma_f32_32x32x16_bf16 v[224:239], a[0:3], v[128:131], v[96:111]
    ds_read_b128 a[12:15], v2 offset:8368
    v_cvt_pk_bf16_f32 v27, v214, v215
    v_add_f32 v9, v9, v215
    v_exp_f32 v200, v200
    s_add_u32 m0, m0, 1024
    v_mfma_f32_32x32x16_bf16 v[240:255], a[0:3], v[160:163], v[112:127]
    buffer_load_dwordx4 v15, s[16:19], s64 offen lds
    v_add_f32 v8, v8, v200
    v_exp_f32 v201, v201
    v_mfma_f32_32x32x16_bf16 v[224:239], a[4:7], v[132:135], v[224:239]
    ds_read_b128 a[0:3], v3 offset:8320
    v_cvt_pk_bf16_f32 v20, v200, v201
    v_add_f32 v8, v8, v201
    v_exp_f32 v202, v202
    v_mfma_f32_32x32x16_bf16 v[240:255], a[4:7], v[164:167], v[240:255]
    v_add_f32 v8, v8, v202
    v_exp_f32 v203, v203
    s_waitcnt lgkmcnt(1)
    s_add_u32 s64, s64, 8192
    v_mfma_f32_32x32x16_bf16 v[224:239], a[8:11], v[136:139], v[224:239]
    ds_read_b128 a[4:7], v3 offset:8336
    v_cvt_pk_bf16_f32 v21, v202, v203
    v_add_f32 v8, v8, v203
    v_exp_f32 v204, v204
    v_mfma_f32_32x32x16_bf16 v[240:255], a[8:11], v[168:171], v[240:255]
    v_add_f32 v8, v8, v204
    v_exp_f32 v205, v205
    v_mfma_f32_32x32x16_bf16 v[224:239], a[12:15], v[140:143], v[224:239]
    ds_read_b128 a[8:11], v3 offset:8352
    v_cvt_pk_bf16_f32 v22, v204, v205
    v_add_f32 v8, v8, v205
    v_exp_f32 v206, v206
    v_mfma_f32_32x32x16_bf16 v[240:255], a[12:15], v[172:175], v[240:255]
    v_add_f32 v8, v8, v206
    v_exp_f32 v207, v207
    s_waitcnt lgkmcnt(1)
    v_mfma_f32_32x32x16_bf16 v[224:239], a[0:3], v[144:147], v[224:239]
    ds_read_b128 a[12:15], v3 offset:8368
    v_cvt_pk_bf16_f32 v23, v206, v207
    v_add_f32 v8, v8, v207
    v_exp_f32 v216, v216
    v_add_u32 v2, s68, v2
    v_mfma_f32_32x32x16_bf16 v[240:255], a[0:3], v[176:179], v[240:255]
    v_add_f32 v9, v9, v216
    v_exp_f32 v217, v217
    v_add_u32 v3, s68, v3
    v_add_u32 v4, s69, v4
    v_mfma_f32_32x32x16_bf16 v[224:239], a[4:7], v[148:151], v[224:239]
    ds_read_b64_tr_b16 a[0:1], v4 offset:0
    v_cvt_pk_bf16_f32 v28, v216, v217
    v_add_f32 v9, v9, v217
    v_exp_f32 v218, v218
    buffer_load_dwordx4 a[252:255], v14, s[44:47], s73 offen
    v_mfma_f32_32x32x16_bf16 v[240:255], a[4:7], v[180:183], v[240:255]
    ds_read_b64_tr_b16 a[2:3], v4 offset:512
    v_add_f32 v9, v9, v218
    v_exp_f32 v219, v219
    s_waitcnt lgkmcnt(2)
    s_add_u32 s73, s73, 1024
    v_mfma_f32_32x32x16_bf16 v[224:239], a[8:11], v[152:155], v[224:239]
    ds_read_b64_tr_b16 a[4:5], v4 offset:64
    v_cvt_pk_bf16_f32 v29, v218, v219
    v_add_f32 v9, v9, v219
    v_exp_f32 v220, v220
    s_sub_u32 s68, 0, s68
    v_mfma_f32_32x32x16_bf16 v[240:255], a[8:11], v[184:187], v[240:255]
    ds_read_b64_tr_b16 a[6:7], v4 offset:576
    v_add_f32 v9, v9, v220
    v_exp_f32 v221, v221
    s_sub_u32 s69, 0, s69
    v_mfma_f32_32x32x16_bf16 v[224:239], a[12:15], v[156:159], v[224:239]
    ds_read_b64_tr_b16 a[8:9], v4 offset:128
    v_cvt_pk_bf16_f32 v30, v220, v221
    v_add_f32 v9, v9, v221
    v_exp_f32 v222, v222
    s_add_u32 s61, s61, 1
    v_mfma_f32_32x32x16_bf16 v[240:255], a[12:15], v[188:191], v[240:255]
    ds_read_b64_tr_b16 a[10:11], v4 offset:640
    v_add_f32 v9, v9, v222
    v_exp_f32 v223, v223
    s_waitcnt lgkmcnt(2)
    v_cvt_pk_bf16_f32 v31, v222, v223
    v_add_f32 v9, v9, v223
    s_cmp_lt_u32 s61, 7
    s_cbranch_scc1 L_al
    v_and_b32 v10, 15, v1
    v_lshrrev_b32 v11, 4, v1
    v_lshlrev_b32 v10, 4, v10
    v_lshlrev_b32 v11, 13, v11
    v_add_u32 v10, v10, v11
    s_lshl_b32 s73, s54, 8
    v_add_u32 v10, s73, v10
    v_add_u32 v11, 4096, v10
    s_mov_b32 s74, 32768
    s_mov_b32 s75, 65536
    v_lshlrev_b32 v12, 2, v1
    buffer_load_dword a224, v12, s[40:43], 0 offen sc0 sc1
    v_mul_u32_u24 v15, 7168, v0
    s_lshl_b32 s76, s80, 4
    v_add_u32 v15, s76, v15
    v_mfma_f32_32x32x16_bf16 a[64:79], a[0:3], v[16:19], a[64:79]
    ds_read_b64_tr_b16 a[12:13], v4 offset:192
    v_mfma_f32_32x32x16_bf16 a[128:143], a[0:3], v[24:27], a[128:143]
    ds_read_b64_tr_b16 a[14:15], v4 offset:704
    buffer_load_dwordx4 a[192:195], v15, s[28:31], 0 offen
    v_mfma_f32_32x32x16_bf16 a[80:95], a[4:7], v[16:19], a[80:95]
    ds_read_b64_tr_b16 a[0:1], v4 offset:1024
    v_exp_f32 v224, v224
    v_exp_f32 v225, v225
    v_mfma_f32_32x32x16_bf16 a[144:159], a[4:7], v[24:27], a[144:159]
    ds_read_b64_tr_b16 a[2:3], v4 offset:1536
    v_add_f32 v8, v8, v224
    v_exp_f32 v226, v226
    v_exp_f32 v227, v227
    s_waitcnt lgkmcnt(2)
    v_mfma_f32_32x32x16_bf16 a[96:111], a[8:11], v[16:19], a[96:111]
    ds_read_b64_tr_b16 a[4:5], v4 offset:1088
    v_add_f32 v8, v8, v225
    v_add_f32 v8, v8, v226
    v_exp_f32 v228, v228
    v_exp_f32 v229, v229
    v_mfma_f32_32x32x16_bf16 a[160:175], a[8:11], v[24:27], a[160:175]
    ds_read_b64_tr_b16 a[6:7], v4 offset:1600
    v_add_f32 v8, v8, v227
    v_add_f32 v8, v8, v228
    v_exp_f32 v230, v230
    v_exp_f32 v231, v231
    v_mfma_f32_32x32x16_bf16 a[112:127], a[12:15], v[16:19], a[112:127]
    ds_read_b64_tr_b16 a[8:9], v4 offset:1152
    v_add_f32 v8, v8, v229
    v_add_f32 v8, v8, v230
    v_exp_f32 v240, v240
    v_exp_f32 v241, v241
    v_mfma_f32_32x32x16_bf16 a[176:191], a[12:15], v[24:27], a[176:191]
    ds_read_b64_tr_b16 a[10:11], v4 offset:1664
    v_cvt_pk_bf16_f32 v16, v224, v225
    v_exp_f32 v242, v242
    v_exp_f32 v243, v243
    s_waitcnt lgkmcnt(2)
    v_mfma_f32_32x32x16_bf16 a[64:79], a[0:3], v[20:23], a[64:79]
    ds_read_b64_tr_b16 a[12:13], v4 offset:1216
    v_cvt_pk_bf16_f32 v17, v226, v227
    v_cvt_pk_bf16_f32 v18, v228, v229
    v_exp_f32 v244, v244
    v_exp_f32 v245, v245
    v_mfma_f32_32x32x16_bf16 a[128:143], a[0:3], v[28:31], a[128:143]
    ds_read_b64_tr_b16 a[14:15], v4 offset:1728
    v_exp_f32 v246, v246
    v_exp_f32 v247, v247
    s_waitcnt vmcnt(8)
    s_barrier
    v_mfma_f32_32x32x16_bf16 a[80:95], a[4:7], v[20:23], a[80:95]
    ds_read_b64_tr_b16 a[0:1], v4 offset:8384
    v_cvt_pk_bf16_f32 v19, v230, v231
    v_cvt_pk_bf16_f32 v24, v240, v241
    v_exp_f32 v232, v232
    v_exp_f32 v233, v233
    v_mfma_f32_32x32x16_bf16 a[144:159], a[4:7], v[28:31], a[144:159]
    ds_read_b64_tr_b16 a[2:3], v4 offset:8896
    v_cvt_pk_bf16_f32 v25, v242, v243
    v_exp_f32 v234, v234
    v_exp_f32 v235, v235
    s_waitcnt lgkmcnt(2)
    v_mfma_f32_32x32x16_bf16 a[96:111], a[8:11], v[20:23], a[96:111]
    ds_read_b64_tr_b16 a[4:5], v4 offset:8448
    v_cvt_pk_bf16_f32 v26, v244, v245
    v_cvt_pk_bf16_f32 v27, v246, v247
    v_exp_f32 v236, v236
    v_exp_f32 v237, v237
    v_mfma_f32_32x32x16_bf16 a[160:175], a[8:11], v[28:31], a[160:175]
    ds_read_b64_tr_b16 a[6:7], v4 offset:8960
    v_add_f32 v8, v8, v231
    v_add_f32 v9, v9, v240
    v_exp_f32 v238, v238
    v_exp_f32 v239, v239
    v_mfma_f32_32x32x16_bf16 a[112:127], a[12:15], v[20:23], a[112:127]
    ds_read_b64_tr_b16 a[8:9], v4 offset:8512
    v_add_f32 v9, v9, v241
    v_add_f32 v9, v9, v242
    v_exp_f32 v248, v248
    v_exp_f32 v249, v249
    v_mfma_f32_32x32x16_bf16 a[176:191], a[12:15], v[28:31], a[176:191]
    ds_read_b64_tr_b16 a[10:11], v4 offset:9024
    v_cvt_pk_bf16_f32 v20, v232, v233
    v_cvt_pk_bf16_f32 v21, v234, v235
    v_cvt_pk_bf16_f32 v22, v236, v237
    v_exp_f32 v250, v250
    s_waitcnt lgkmcnt(2)
    v_mfma_f32_32x32x16_bf16 a[64:79], a[0:3], v[16:19], a[64:79]
    ds_read_b64_tr_b16 a[12:13], v4 offset:8576
    v_cvt_pk_bf16_f32 v23, v238, v239
    v_cvt_pk_bf16_f32 v28, v248, v249
    v_add_f32 v9, v9, v243
    v_add_f32 v9, v9, v244
    v_exp_f32 v251, v251
    v_mfma_f32_32x32x16_bf16 a[128:143], a[0:3], v[24:27], a[128:143]
    ds_read_b64_tr_b16 a[14:15], v4 offset:9088
    v_cvt_pk_bf16_f32 v29, v250, v251
    v_add_f32 v9, v9, v245
    v_add_f32 v9, v9, v246
    v_exp_f32 v252, v252
    buffer_load_dwordx4 v[32:35], v10, s[44:47], 0 offen offset:0
    v_mfma_f32_32x32x16_bf16 a[80:95], a[4:7], v[16:19], a[80:95]
    ds_read_b64_tr_b16 a[0:1], v4 offset:9408
    v_add_f32 v9, v9, v247
    v_add_f32 v8, v8, v232
    v_add_f32 v8, v8, v233
    v_add_f32 v8, v8, v234
    v_exp_f32 v253, v253
    v_mfma_f32_32x32x16_bf16 a[144:159], a[4:7], v[24:27], a[144:159]
    ds_read_b64_tr_b16 a[2:3], v4 offset:9920
    v_cvt_pk_bf16_f32 v30, v252, v253
    v_add_f32 v8, v8, v235
    v_exp_f32 v254, v254
    s_waitcnt lgkmcnt(2)
    buffer_load_dwordx4 v[36:39], v10, s[44:47], 0 offen offset:1024
    v_mfma_f32_32x32x16_bf16 a[96:111], a[8:11], v[16:19], a[96:111]
    ds_read_b64_tr_b16 a[4:5], v4 offset:9472
    v_add_f32 v8, v8, v236
    v_add_f32 v8, v8, v237
    v_add_f32 v8, v8, v238
    v_add_f32 v8, v8, v239
    v_exp_f32 v255, v255
    v_mfma_f32_32x32x16_bf16 a[160:175], a[8:11], v[24:27], a[160:175]
    ds_read_b64_tr_b16 a[6:7], v4 offset:9984
    v_cvt_pk_bf16_f32 v31, v254, v255
    v_add_f32 v9, v9, v248
    v_add_f32 v9, v9, v249
    v_add_f32 v9, v9, v250
    v_add_f32 v9, v9, v251
    buffer_load_dwordx4 v[40:43], v10, s[44:47], 0 offen offset:2048
    v_mfma_f32_32x32x16_bf16 a[112:127], a[12:15], v[16:19], a[112:127]
    ds_read_b64_tr_b16 a[8:9], v4 offset:9536
    v_add_f32 v9, v9, v252
    v_add_f32 v9, v9, v253
    v_add_f32 v9, v9, v254
    v_add_f32 v9, v9, v255
    v_mfma_f32_32x32x16_bf16 a[176:191], a[12:15], v[24:27], a[176:191]
    ds_read_b64_tr_b16 a[10:11], v4 offset:10048
    s_waitcnt lgkmcnt(2)
    buffer_load_dwordx4 v[44:47], v10, s[44:47], 0 offen offset:3072
    v_mfma_f32_32x32x16_bf16 a[64:79], a[0:3], v[20:23], a[64:79]
    ds_read_b64_tr_b16 a[12:13], v4 offset:9600
    v_mfma_f32_32x32x16_bf16 a[128:143], a[0:3], v[28:31], a[128:143]
    ds_read_b64_tr_b16 a[14:15], v4 offset:10112
    buffer_load_dwordx4 v[48:51], v11, s[44:47], 0 offen offset:0
    v_mfma_f32_32x32x16_bf16 a[80:95], a[4:7], v[20:23], a[80:95]
    v_mfma_f32_32x32x16_bf16 a[144:159], a[4:7], v[28:31], a[144:159]
    s_waitcnt lgkmcnt(0)
    buffer_load_dwordx4 v[52:55], v11, s[44:47], 0 offen offset:1024
    v_mfma_f32_32x32x16_bf16 a[96:111], a[8:11], v[20:23], a[96:111]
    v_mfma_f32_32x32x16_bf16 a[160:175], a[8:11], v[28:31], a[160:175]
    buffer_load_dwordx4 v[56:59], v11, s[44:47], 0 offen offset:2048
    v_mfma_f32_32x32x16_bf16 a[112:127], a[12:15], v[20:23], a[112:127]
    v_mfma_f32_32x32x16_bf16 a[176:191], a[12:15], v[28:31], a[176:191]
    buffer_load_dwordx4 v[60:63], v11, s[44:47], 0 offen offset:3072
    v_mov_b32 v12, v8
    v_mov_b32 v13, v9
    s_mov_b32 s73, 0x5d800000
    v_permlane32_swap_b32 v8, v12
    v_permlane32_swap_b32 v9, v13
    v_add_f32 v8, v8, v12
    v_add_f32 v9, v9, v13
    v_add_f32 v13, v8, v9
    v_cmp_nle_f32 vcc, v13, s73
    v_rcp_f32 v12, v8
    v_rcp_f32 v14, v9
    s_cmp_lg_u64 vcc, 0
    s_cselect_b32 s76, 1, 0
    v_mov_b32 v8, s76
    s_lshl_b32 s77, s54, 2
    s_add_u32 s77, s77, 66816
    v_mov_b32 v9, s77
    ds_write_b32 v9, v8
    s_waitcnt vmcnt(11) lgkmcnt(0)
    s_barrier
    v_mov_b32 v9, 66816
    ds_read_b128 v[16:19], v9
    v_accvgpr_read_b32 v192, a64
    v_accvgpr_read_b32 v193, a65
    v_accvgpr_read_b32 v194, a66
    v_accvgpr_read_b32 v195, a67
    buffer_load_dwordx4 v[64:67], v10, s[44:47], s74 offen offset:0
    v_accvgpr_read_b32 v196, a68
    v_accvgpr_read_b32 v197, a69
    v_accvgpr_read_b32 v198, a70
    v_accvgpr_read_b32 v199, a71
    v_accvgpr_read_b32 v200, a72
    v_accvgpr_read_b32 v201, a73
    v_accvgpr_read_b32 v202, a74
    v_accvgpr_read_b32 v203, a75
    buffer_load_dwordx4 v[68:71], v10, s[44:47], s74 offen offset:1024
    v_accvgpr_read_b32 v204, a76
    v_accvgpr_read_b32 v205, a77
    v_accvgpr_read_b32 v206, a78
    v_accvgpr_read_b32 v207, a79
    v_pk_mul_f32 v[192:193], v[192:193], v[12:13] op_sel_hi:[1,0]
    v_pk_mul_f32 v[194:195], v[194:195], v[12:13] op_sel_hi:[1,0]
    v_pk_mul_f32 v[196:197], v[196:197], v[12:13] op_sel_hi:[1,0]
    v_pk_mul_f32 v[198:199], v[198:199], v[12:13] op_sel_hi:[1,0]
    v_pk_mul_f32 v[200:201], v[200:201], v[12:13] op_sel_hi:[1,0]
    v_pk_mul_f32 v[202:203], v[202:203], v[12:13] op_sel_hi:[1,0]
    v_pk_mul_f32 v[204:205], v[204:205], v[12:13] op_sel_hi:[1,0]
    v_pk_mul_f32 v[206:207], v[206:207], v[12:13] op_sel_hi:[1,0]
    v_accvgpr_read_b32 v208, a80
    v_accvgpr_read_b32 v209, a81
    v_accvgpr_read_b32 v210, a82
    v_accvgpr_read_b32 v211, a83
    buffer_load_dwordx4 v[72:75], v10, s[44:47], s74 offen offset:2048
    v_accvgpr_read_b32 v212, a84
    v_accvgpr_read_b32 v213, a85
    v_accvgpr_read_b32 v214, a86
    v_accvgpr_read_b32 v215, a87
    v_accvgpr_read_b32 v216, a88
    v_accvgpr_read_b32 v217, a89
    v_accvgpr_read_b32 v218, a90
    v_accvgpr_read_b32 v219, a91
    buffer_load_dwordx4 v[76:79], v10, s[44:47], s74 offen offset:3072
    v_accvgpr_read_b32 v220, a92
    v_accvgpr_read_b32 v221, a93
    v_accvgpr_read_b32 v222, a94
    v_accvgpr_read_b32 v223, a95
    v_pk_mul_f32 v[208:209], v[208:209], v[12:13] op_sel_hi:[1,0]
    v_pk_mul_f32 v[210:211], v[210:211], v[12:13] op_sel_hi:[1,0]
    v_pk_mul_f32 v[212:213], v[212:213], v[12:13] op_sel_hi:[1,0]
    v_pk_mul_f32 v[214:215], v[214:215], v[12:13] op_sel_hi:[1,0]
    v_pk_mul_f32 v[216:217], v[216:217], v[12:13] op_sel_hi:[1,0]
    v_pk_mul_f32 v[218:219], v[218:219], v[12:13] op_sel_hi:[1,0]
    v_pk_mul_f32 v[220:221], v[220:221], v[12:13] op_sel_hi:[1,0]
    v_pk_mul_f32 v[222:223], v[222:223], v[12:13] op_sel_hi:[1,0]
    v_accvgpr_read_b32 v224, a96
    v_accvgpr_read_b32 v225, a97
    v_accvgpr_read_b32 v226, a98
    v_accvgpr_read_b32 v227, a99
    buffer_load_dwordx4 v[80:83], v11, s[44:47], s74 offen offset:0
    v_accvgpr_read_b32 v228, a100
    v_accvgpr_read_b32 v229, a101
    v_accvgpr_read_b32 v230, a102
    v_accvgpr_read_b32 v231, a103
    v_accvgpr_read_b32 v232, a104
    v_accvgpr_read_b32 v233, a105
    v_accvgpr_read_b32 v234, a106
    v_accvgpr_read_b32 v235, a107
    buffer_load_dwordx4 v[84:87], v11, s[44:47], s74 offen offset:1024
    v_accvgpr_read_b32 v236, a108
    v_accvgpr_read_b32 v237, a109
    v_accvgpr_read_b32 v238, a110
    v_accvgpr_read_b32 v239, a111
    v_pk_mul_f32 v[224:225], v[224:225], v[12:13] op_sel_hi:[1,0]
    v_pk_mul_f32 v[226:227], v[226:227], v[12:13] op_sel_hi:[1,0]
    v_pk_mul_f32 v[228:229], v[228:229], v[12:13] op_sel_hi:[1,0]
    v_pk_mul_f32 v[230:231], v[230:231], v[12:13] op_sel_hi:[1,0]
    v_pk_mul_f32 v[232:233], v[232:233], v[12:13] op_sel_hi:[1,0]
    v_pk_mul_f32 v[234:235], v[234:235], v[12:13] op_sel_hi:[1,0]
    v_pk_mul_f32 v[236:237], v[236:237], v[12:13] op_sel_hi:[1,0]
    v_pk_mul_f32 v[238:239], v[238:239], v[12:13] op_sel_hi:[1,0]
    v_accvgpr_read_b32 v240, a112
    v_accvgpr_read_b32 v241, a113
    v_accvgpr_read_b32 v242, a114
    v_accvgpr_read_b32 v243, a115
    buffer_load_dwordx4 v[88:91], v11, s[44:47], s74 offen offset:2048
    v_accvgpr_read_b32 v244, a116
    v_accvgpr_read_b32 v245, a117
    v_accvgpr_read_b32 v246, a118
    v_accvgpr_read_b32 v247, a119
    v_accvgpr_read_b32 v248, a120
    v_accvgpr_read_b32 v249, a121
    v_accvgpr_read_b32 v250, a122
    v_accvgpr_read_b32 v251, a123
    buffer_load_dwordx4 v[92:95], v11, s[44:47], s74 offen offset:3072
    v_accvgpr_read_b32 v252, a124
    v_accvgpr_read_b32 v253, a125
    v_accvgpr_read_b32 v254, a126
    v_accvgpr_read_b32 v255, a127
    v_pk_mul_f32 v[240:241], v[240:241], v[12:13] op_sel_hi:[1,0]
    v_pk_mul_f32 v[242:243], v[242:243], v[12:13] op_sel_hi:[1,0]
    v_pk_mul_f32 v[244:245], v[244:245], v[12:13] op_sel_hi:[1,0]
    v_pk_mul_f32 v[246:247], v[246:247], v[12:13] op_sel_hi:[1,0]
    v_pk_mul_f32 v[248:249], v[248:249], v[12:13] op_sel_hi:[1,0]
    v_pk_mul_f32 v[250:251], v[250:251], v[12:13] op_sel_hi:[1,0]
    v_pk_mul_f32 v[252:253], v[252:253], v[12:13] op_sel_hi:[1,0]
    v_pk_mul_f32 v[254:255], v[254:255], v[12:13] op_sel_hi:[1,0]
    s_waitcnt lgkmcnt(0)
    v_or_b32 v9, v16, v17
    v_or3_b32 v9, v9, v18, v19
    s_nop 0
    v_readfirstlane_b32 s73, v9
    s_nop 3
    s_cmp_eq_u32 s72, 0
    s_cselect_b32 s73, s73, 0
    s_cmp_lg_u32 s73, 0
    s_cbranch_scc1 L_fallback
    v_and_b32 v8, 31, v1
    v_mul_u32_u24 v8, 1040, v8
    v_lshrrev_b32 v9, 5, v1
    v_lshlrev_b32 v9, 4, v9
    v_add_u32 v8, v8, v9
    s_lshl_b32 s73, s54, 8
    s_add_u32 s73, s73, 0
    v_add_u32 v8, s73, v8
    v_lshlrev_b32 v13, 2, v0
    s_lshl_b32 s77, s80, 13
    s_add_u32 s78, s77, 4096
    v_cvt_pk_bf16_f32 v128, v192, v193
    v_cvt_pk_bf16_f32 v129, v194, v195
    v_cvt_pk_bf16_f32 v130, v196, v197
    v_cvt_pk_bf16_f32 v131, v198, v199
    v_cvt_pk_bf16_f32 v132, v200, v201
    v_cvt_pk_bf16_f32 v133, v202, v203
    v_cvt_pk_bf16_f32 v134, v204, v205
    v_cvt_pk_bf16_f32 v135, v206, v207
    ds_write_b128 v8, v[128:131] offset:0
    ds_write_b128 v8, v[132:135] offset:32
    v_cvt_pk_bf16_f32 v136, v208, v209
    v_cvt_pk_bf16_f32 v137, v210, v211
    v_cvt_pk_bf16_f32 v138, v212, v213
    v_cvt_pk_bf16_f32 v139, v214, v215
    v_cvt_pk_bf16_f32 v140, v216, v217
    v_cvt_pk_bf16_f32 v141, v218, v219
    v_cvt_pk_bf16_f32 v142, v220, v221
    v_cvt_pk_bf16_f32 v143, v222, v223
    ds_write_b128 v8, v[136:139] offset:64
    ds_write_b128 v8, v[140:143] offset:96
    v_cvt_pk_bf16_f32 v144, v224, v225
    v_cvt_pk_bf16_f32 v145, v226, v227
    v_cvt_pk_bf16_f32 v146, v228, v229
    v_cvt_pk_bf16_f32 v147, v230, v231
    v_cvt_pk_bf16_f32 v148, v232, v233
    v_cvt_pk_bf16_f32 v149, v234, v235
    v_cvt_pk_bf16_f32 v150, v236, v237
    v_cvt_pk_bf16_f32 v151, v238, v239
    ds_write_b128 v8, v[144:147] offset:128
    ds_write_b128 v8, v[148:151] offset:160
    v_cvt_pk_bf16_f32 v152, v240, v241
    v_cvt_pk_bf16_f32 v153, v242, v243
    v_cvt_pk_bf16_f32 v154, v244, v245
    v_cvt_pk_bf16_f32 v155, v246, v247
    v_cvt_pk_bf16_f32 v156, v248, v249
    v_cvt_pk_bf16_f32 v157, v250, v251
    v_cvt_pk_bf16_f32 v158, v252, v253
    v_cvt_pk_bf16_f32 v159, v254, v255
    ds_write_b128 v8, v[152:155] offset:192
    ds_write_b128 v8, v[156:159] offset:224
    v_accvgpr_read_b32 v192, a128
    v_accvgpr_read_b32 v193, a129
    v_accvgpr_read_b32 v194, a130
    v_accvgpr_read_b32 v195, a131
    v_accvgpr_read_b32 v196, a132
    v_accvgpr_read_b32 v197, a133
    v_accvgpr_read_b32 v198, a134
    v_accvgpr_read_b32 v199, a135
    v_accvgpr_read_b32 v200, a136
    v_accvgpr_read_b32 v201, a137
    v_accvgpr_read_b32 v202, a138
    v_accvgpr_read_b32 v203, a139
    v_accvgpr_read_b32 v204, a140
    v_accvgpr_read_b32 v205, a141
    v_accvgpr_read_b32 v206, a142
    v_accvgpr_read_b32 v207, a143
    v_pk_mul_f32 v[192:193], v[192:193], v[14:15] op_sel_hi:[1,0]
    v_pk_mul_f32 v[194:195], v[194:195], v[14:15] op_sel_hi:[1,0]
    v_pk_mul_f32 v[196:197], v[196:197], v[14:15] op_sel_hi:[1,0]
    v_pk_mul_f32 v[198:199], v[198:199], v[14:15] op_sel_hi:[1,0]
    v_pk_mul_f32 v[200:201], v[200:201], v[14:15] op_sel_hi:[1,0]
    v_pk_mul_f32 v[202:203], v[202:203], v[14:15] op_sel_hi:[1,0]
    v_pk_mul_f32 v[204:205], v[204:205], v[14:15] op_sel_hi:[1,0]
    v_pk_mul_f32 v[206:207], v[206:207], v[14:15] op_sel_hi:[1,0]
    v_cvt_pk_bf16_f32 v160, v192, v193
    v_cvt_pk_bf16_f32 v161, v194, v195
    v_cvt_pk_bf16_f32 v162, v196, v197
    v_cvt_pk_bf16_f32 v163, v198, v199
    v_cvt_pk_bf16_f32 v164, v200, v201
    v_cvt_pk_bf16_f32 v165, v202, v203
    v_cvt_pk_bf16_f32 v166, v204, v205
    v_cvt_pk_bf16_f32 v167, v206, v207
    ds_write_b128 v8, v[160:163] offset:33280
    ds_write_b128 v8, v[164:167] offset:33312
    buffer_load_dwordx4 a[196:199], v15, s[28:31], 0 offen offset:3584
    v_accvgpr_read_b32 v208, a144
    v_accvgpr_read_b32 v209, a145
    v_accvgpr_read_b32 v210, a146
    v_accvgpr_read_b32 v211, a147
    v_accvgpr_read_b32 v212, a148
    v_accvgpr_read_b32 v213, a149
    v_accvgpr_read_b32 v214, a150
    v_accvgpr_read_b32 v215, a151
    v_accvgpr_read_b32 v216, a152
    v_accvgpr_read_b32 v217, a153
    v_accvgpr_read_b32 v218, a154
    v_accvgpr_read_b32 v219, a155
    v_accvgpr_read_b32 v220, a156
    v_accvgpr_read_b32 v221, a157
    v_accvgpr_read_b32 v222, a158
    v_accvgpr_read_b32 v223, a159
    v_pk_mul_f32 v[208:209], v[208:209], v[14:15] op_sel_hi:[1,0]
    v_pk_mul_f32 v[210:211], v[210:211], v[14:15] op_sel_hi:[1,0]
    v_pk_mul_f32 v[212:213], v[212:213], v[14:15] op_sel_hi:[1,0]
    v_pk_mul_f32 v[214:215], v[214:215], v[14:15] op_sel_hi:[1,0]
    v_pk_mul_f32 v[216:217], v[216:217], v[14:15] op_sel_hi:[1,0]
    v_pk_mul_f32 v[218:219], v[218:219], v[14:15] op_sel_hi:[1,0]
    v_pk_mul_f32 v[220:221], v[220:221], v[14:15] op_sel_hi:[1,0]
    v_pk_mul_f32 v[222:223], v[222:223], v[14:15] op_sel_hi:[1,0]
    v_cvt_pk_bf16_f32 v168, v208, v209
    v_cvt_pk_bf16_f32 v169, v210, v211
    v_cvt_pk_bf16_f32 v170, v212, v213
    v_cvt_pk_bf16_f32 v171, v214, v215
    v_cvt_pk_bf16_f32 v172, v216, v217
    v_cvt_pk_bf16_f32 v173, v218, v219
    v_cvt_pk_bf16_f32 v174, v220, v221
    v_cvt_pk_bf16_f32 v175, v222, v223
    ds_write_b128 v8, v[168:171] offset:33344
    ds_write_b128 v8, v[172:175] offset:33376
    buffer_load_dwordx4 a[200:203], v15, s[32:35], 0 offen
    v_accvgpr_read_b32 v224, a160
    v_accvgpr_read_b32 v225, a161
    v_accvgpr_read_b32 v226, a162
    v_accvgpr_read_b32 v227, a163
    v_accvgpr_read_b32 v228, a164
    v_accvgpr_read_b32 v229, a165
    v_accvgpr_read_b32 v230, a166
    v_accvgpr_read_b32 v231, a167
    v_accvgpr_read_b32 v232, a168
    v_accvgpr_read_b32 v233, a169
    v_accvgpr_read_b32 v234, a170
    v_accvgpr_read_b32 v235, a171
    v_accvgpr_read_b32 v236, a172
    v_accvgpr_read_b32 v237, a173
    v_accvgpr_read_b32 v238, a174
    v_accvgpr_read_b32 v239, a175
    v_pk_mul_f32 v[224:225], v[224:225], v[14:15] op_sel_hi:[1,0]
    v_pk_mul_f32 v[226:227], v[226:227], v[14:15] op_sel_hi:[1,0]
    v_pk_mul_f32 v[228:229], v[228:229], v[14:15] op_sel_hi:[1,0]
    v_pk_mul_f32 v[230:231], v[230:231], v[14:15] op_sel_hi:[1,0]
    v_pk_mul_f32 v[232:233], v[232:233], v[14:15] op_sel_hi:[1,0]
    v_pk_mul_f32 v[234:235], v[234:235], v[14:15] op_sel_hi:[1,0]
    v_pk_mul_f32 v[236:237], v[236:237], v[14:15] op_sel_hi:[1,0]
    v_pk_mul_f32 v[238:239], v[238:239], v[14:15] op_sel_hi:[1,0]
    v_cvt_pk_bf16_f32 v176, v224, v225
    v_cvt_pk_bf16_f32 v177, v226, v227
    v_cvt_pk_bf16_f32 v178, v228, v229
    v_cvt_pk_bf16_f32 v179, v230, v231
    v_cvt_pk_bf16_f32 v180, v232, v233
    v_cvt_pk_bf16_f32 v181, v234, v235
    v_cvt_pk_bf16_f32 v182, v236, v237
    v_cvt_pk_bf16_f32 v183, v238, v239
    ds_write_b128 v8, v[176:179] offset:33408
    ds_write_b128 v8, v[180:183] offset:33440
    buffer_load_dwordx4 a[204:207], v15, s[32:35], 0 offen offset:3584
    v_accvgpr_read_b32 v240, a176
    v_accvgpr_read_b32 v241, a177
    v_accvgpr_read_b32 v242, a178
    v_accvgpr_read_b32 v243, a179
    v_accvgpr_read_b32 v244, a180
    v_accvgpr_read_b32 v245, a181
    v_accvgpr_read_b32 v246, a182
    v_accvgpr_read_b32 v247, a183
    v_accvgpr_read_b32 v248, a184
    v_accvgpr_read_b32 v249, a185
    v_accvgpr_read_b32 v250, a186
    v_accvgpr_read_b32 v251, a187
    v_accvgpr_read_b32 v252, a188
    v_accvgpr_read_b32 v253, a189
    v_accvgpr_read_b32 v254, a190
    v_accvgpr_read_b32 v255, a191
    v_pk_mul_f32 v[240:241], v[240:241], v[14:15] op_sel_hi:[1,0]
    v_pk_mul_f32 v[242:243], v[242:243], v[14:15] op_sel_hi:[1,0]
    v_pk_mul_f32 v[244:245], v[244:245], v[14:15] op_sel_hi:[1,0]
    v_pk_mul_f32 v[246:247], v[246:247], v[14:15] op_sel_hi:[1,0]
    v_pk_mul_f32 v[248:249], v[248:249], v[14:15] op_sel_hi:[1,0]
    v_pk_mul_f32 v[250:251], v[250:251], v[14:15] op_sel_hi:[1,0]
    v_pk_mul_f32 v[252:253], v[252:253], v[14:15] op_sel_hi:[1,0]
    v_pk_mul_f32 v[254:255], v[254:255], v[14:15] op_sel_hi:[1,0]
    v_cvt_pk_bf16_f32 v184, v240, v241
    v_cvt_pk_bf16_f32 v185, v242, v243
    v_cvt_pk_bf16_f32 v186, v244, v245
    v_cvt_pk_bf16_f32 v187, v246, v247
    v_cvt_pk_bf16_f32 v188, v248, v249
    v_cvt_pk_bf16_f32 v189, v250, v251
    v_cvt_pk_bf16_f32 v190, v252, v253
    v_cvt_pk_bf16_f32 v191, v254, v255
    ds_write_b128 v8, v[184:187] offset:33472
    ds_write_b128 v8, v[188:191] offset:33504
    buffer_load_dword a208, v13, s[36:39], s77 offen offset:0
    buffer_load_dword a209, v13, s[36:39], s77 offen offset:1024
    buffer_load_dword a210, v13, s[36:39], s77 offen offset:2048
    buffer_load_dword a211, v13, s[36:39], s77 offen offset:3072
    buffer_load_dword a212, v13, s[36:39], s78 offen offset:0
    buffer_load_dword a213, v13, s[36:39], s78 offen offset:1024
    buffer_load_dword a214, v13, s[36:39], s78 offen offset:2048
    buffer_load_dword a215, v13, s[36:39], s78 offen offset:3072
    v_mov_b32 v24, v10
    v_add_u32 v25, 1024, v10
    v_add_u32 v26, 2048, v10
    v_add_u32 v27, 3072, v10
    v_add_u32 v28, 4096, v10
    v_add_u32 v29, 5120, v10
    v_add_u32 v30, 6144, v10
    v_add_u32 v31, 7168, v10
    s_mov_b32 s4, s44
    s_mov_b32 s5, s45
    s_mov_b32 s6, 524288
    s_mov_b32 s7, 0x20000
    s_mov_b32 s60, 32768
    s_mov_b32 s59, 65536
    v_and_b32 v12, 15, v1
    v_lshrrev_b32 v13, 4, v1
    v_mul_u32_u24 v12, 1040, v12
    v_lshlrev_b32 v13, 4, v13
    v_add_u32 v12, v12, v13
    v_add_u32 v7, 0, v12
    s_waitcnt vmcnt(28)
    v_accvgpr_read_b32 v12, a224
    s_mov_b32 s76, 0
L_poll:
    v_cmp_ne_u32 vcc, 0, v12
    s_nop 4
    s_lshr_b32 s77, vcc_hi, 31
    s_or_b32 s77, s77, 0
    s_cmp_eq_u32 vcc_lo, -1
    s_cselect_b32 s78, s77, 0
    s_cmp_eq_u32 s78, 1
    s_cbranch_scc1 L_polled
    s_add_u32 s76, s76, 1
    s_cmp_ge_u32 s76, 0x40000
    s_cbranch_scc1 L_polled
    s_sleep 2
    v_lshlrev_b32 v13, 2, v1
    buffer_load_dword v12, v13, s[40:43], 0 offen sc0 sc1
    s_waitcnt vmcnt(0)
    s_branch L_poll
L_polled:
    v_readlane_b32 s83, v12, 63
    v_max_u32_dpp v12, v12, v12 quad_perm:[1,0,3,2] row_mask:0xf bank_mask:0xf
    s_nop 1
    v_max_u32_dpp v12, v12, v12 quad_perm:[2,3,0,1] row_mask:0xf bank_mask:0xf
    s_nop 1
    v_max_u32_dpp v12, v12, v12 row_half_mirror row_mask:0xf bank_mask:0xf
    s_nop 1
    v_max_u32_dpp v12, v12, v12 row_mirror row_mask:0xf bank_mask:0xf
    v_mov_b32 v13, v12
    s_nop 1
    v_permlane16_swap_b32 v12, v13
    v_max_u32 v12, v12, v13
    s_nop 0
    v_readfirstlane_b32 s85, v12
    s_nop 3
    s_and_b32 s79, s85, 0xffff
    s_sub_u32 s79, 0xffff, s79
    s_and_b32 s79, s79, 0x7ff
    s_lshl_b32 s74, s79, 10
    v_lshlrev_b32 v12, 4, v1
    v_lshlrev_b32 v13, 2, v0
    buffer_load_dwordx4 a[216:219], v12, s[8:11], s74 offen
    buffer_load_dword a220, v13, s[8:11], s74 offen
    s_waitcnt lgkmcnt(0)
    s_barrier
    v_lshlrev_b32 v10, 4, v1
    s_lshl_b32 s73, s52, 21
    s_lshl_b32 s74, s53, 16
    s_add_u32 s73, s73, s74
    s_lshl_b32 s74, s54, 14
    s_add_u32 s73, s73, s74
    v_bfe_u32 v11, v1, 3, 1
    s_and_b32 s74, s52, 1
    v_mov_b32 v12, 0x7ffffff0
    v_cmp_eq_u32 vcc, s74, v11
    v_and_b32 v13, 7, v1
    v_mul_u32_u24 v13, 1040, v13
    v_lshrrev_b32 v14, 4, v1
    v_lshlrev_b32 v14, 6, v14
    v_add_u32 v13, v13, v14
    s_lshl_b32 s75, s54, 8
    s_add_u32 s75, s75, 67840
    v_add_u32 v13, s75, v13
    v_mov_b32 v14, 76032
    v_cndmask_b32 v11, v10, v12, vcc
    v_cndmask_b32 v13, v14, v13, vcc
    s_lshr_b32 s76, s52, 1
    s_cmp_eq_u32 s76, 0
    s_cselect_b64 vcc, -1, 0
    s_nop 0
    v_cndmask_b32 v8, v10, v11, vcc
    s_cmp_eq_u32 s76, 1
    s_cselect_b64 vcc, -1, 0
    s_nop 0
    v_cndmask_b32 v9, v10, v11, vcc
    s_cmp_eq_u32 s76, 2
    s_cselect_b64 vcc, -1, 0
    s_nop 0
    v_cndmask_b32 v12, v10, v11, vcc
    s_cmp_eq_u32 s76, 3
    s_cselect_b64 vcc, -1, 0
    s_nop 0
    v_cndmask_b32 v14, v10, v11, vcc
    s_add_u32 s74, s73, 4096
    s_add_u32 s75, s73, 8192
    s_add_u32 s77, s73, 12288
    s_mov_b32 s99, 1
    s_branch L_gemm
L_otail:
    v_mfma_f32_16x16x32_bf16 v[128:131], v[16:19], a[32:35], v[128:131]
    v_perm_b32 v20, v100, v96, s58
    v_perm_b32 v21, v108, v104, s58
    v_mfma_f32_16x16x32_bf16 v[132:135], v[16:19], a[36:39], v[132:135]
    v_perm_b32 v22, v116, v112, s58
    v_perm_b32 v23, v124, v120, s58
    v_mfma_f32_16x16x32_bf16 v[136:139], v[16:19], a[40:43], v[136:139]
    v_mfma_f32_16x16x32_bf16 v[140:143], v[16:19], a[44:47], v[140:143]
    ds_read_b128 a[0:3], v7 offset:192
    v_mfma_f32_16x16x32_bf16 v[144:147], v[20:23], a[32:35], v[144:147]
    v_perm_b32 v16, v101, v97, s57
    v_perm_b32 v17, v109, v105, s57
    v_mfma_f32_16x16x32_bf16 v[148:151], v[20:23], a[36:39], v[148:151]
    v_perm_b32 v18, v117, v113, s57
    v_perm_b32 v19, v125, v121, s57
    v_mfma_f32_16x16x32_bf16 v[152:155], v[20:23], a[40:43], v[152:155]
    v_mfma_f32_16x16x32_bf16 v[156:159], v[20:23], a[44:47], v[156:159]
    ds_read_b128 a[4:7], v7 offset:16832
    v_mfma_f32_16x16x32_bf16 v[160:163], v[16:19], a[32:35], v[160:163]
    v_perm_b32 v20, v101, v97, s58
    v_perm_b32 v21, v109, v105, s58
    v_mfma_f32_16x16x32_bf16 v[164:167], v[16:19], a[36:39], v[164:167]
    v_perm_b32 v22, v117, v113, s58
    v_perm_b32 v23, v125, v121, s58
    v_mfma_f32_16x16x32_bf16 v[168:171], v[16:19], a[40:43], v[168:171]
    v_mfma_f32_16x16x32_bf16 v[172:175], v[16:19], a[44:47], v[172:175]
    ds_read_b128 a[8:11], v7 offset:33472
    v_mfma_f32_16x16x32_bf16 v[176:179], v[20:23], a[32:35], v[176:179]
    v_perm_b32 v16, v102, v98, s57
    v_perm_b32 v17, v110, v106, s57
    v_mfma_f32_16x16x32_bf16 v[180:183], v[20:23], a[36:39], v[180:183]
    v_perm_b32 v18, v118, v114, s57
    v_perm_b32 v19, v126, v122, s57
    v_mfma_f32_16x16x32_bf16 v[184:187], v[20:23], a[40:43], v[184:187]
    v_mfma_f32_16x16x32_bf16 v[188:191], v[20:23], a[44:47], v[188:191]
    ds_read_b128 a[12:15], v7 offset:50112
    v_mfma_f32_16x16x32_bf16 v[192:195], v[16:19], a[32:35], v[192:195]
    v_perm_b32 v20, v102, v98, s58
    v_perm_b32 v21, v110, v106, s58
    v_mfma_f32_16x16x32_bf16 v[196:199], v[16:19], a[36:39], v[196:199]
    v_perm_b32 v22, v118, v114, s58
    v_perm_b32 v23, v126, v122, s58
    v_mfma_f32_16x16x32_bf16 v[200:203], v[16:19], a[40:43], v[200:203]
    v_mfma_f32_16x16x32_bf16 v[204:207], v[16:19], a[44:47], v[204:207]
    v_mfma_f32_16x16x32_bf16 v[208:211], v[20:23], a[32:35], v[208:211]
    v_perm_b32 v16, v103, v99, s57
    v_perm_b32 v17, v111, v107, s57
    v_mfma_f32_16x16x32_bf16 v[212:215], v[20:23], a[36:39], v[212:215]
    v_perm_b32 v18, v119, v115, s57
    v_perm_b32 v19, v127, v123, s57
    v_mfma_f32_16x16x32_bf16 v[216:219], v[20:23], a[40:43], v[216:219]
    v_mfma_f32_16x16x32_bf16 v[220:223], v[20:23], a[44:47], v[220:223]
    v_mfma_f32_16x16x32_bf16 v[224:227], v[16:19], a[32:35], v[224:227]
    v_perm_b32 v20, v103, v99, s58
    v_perm_b32 v21, v111, v107, s58
    v_mfma_f32_16x16x32_bf16 v[228:231], v[16:19], a[36:39], v[228:231]
    v_perm_b32 v22, v119, v115, s58
    v_perm_b32 v23, v127, v123, s58
    v_mfma_f32_16x16x32_bf16 v[232:235], v[16:19], a[40:43], v[232:235]
    v_mfma_f32_16x16x32_bf16 v[236:239], v[16:19], a[44:47], v[236:239]
    s_waitcnt vmcnt(0)
    v_mfma_f32_16x16x32_bf16 v[240:243], v[20:23], a[32:35], v[240:243]
    v_perm_b32 v16, v36, v32, s57
    v_perm_b32 v17, v44, v40, s57
    v_mfma_f32_16x16x32_bf16 v[244:247], v[20:23], a[36:39], v[244:247]
    v_perm_b32 v18, v52, v48, s57
    v_perm_b32 v19, v60, v56, s57
    v_mfma_f32_16x16x32_bf16 v[248:251], v[20:23], a[40:43], v[248:251]
    v_mfma_f32_16x16x32_bf16 v[252:255], v[20:23], a[44:47], v[252:255]
    s_waitcnt lgkmcnt(0)
    v_perm_b32 v100, v36, v32, s58
    v_perm_b32 v101, v44, v40, s58
    v_perm_b32 v102, v52, v48, s58
    v_perm_b32 v103, v60, v56, s58
    v_mfma_f32_16x16x32_bf16 v[128:131], v[16:19], a[0:3], v[128:131]
    v_perm_b32 v104, v37, v33, s57
    v_perm_b32 v105, v45, v41, s57
    v_perm_b32 v106, v53, v49, s57
    v_perm_b32 v107, v61, v57, s57
    v_mfma_f32_16x16x32_bf16 v[144:147], v[100:103], a[0:3], v[144:147]
    v_perm_b32 v108, v37, v33, s58
    v_perm_b32 v109, v45, v41, s58
    v_perm_b32 v110, v53, v49, s58
    v_perm_b32 v111, v61, v57, s58
    v_mfma_f32_16x16x32_bf16 v[160:163], v[104:107], a[0:3], v[160:163]
    v_perm_b32 v112, v38, v34, s57
    v_perm_b32 v113, v46, v42, s57
    v_perm_b32 v114, v54, v50, s57
    v_perm_b32 v115, v62, v58, s57
    v_mfma_f32_16x16x32_bf16 v[176:179], v[108:111], a[0:3], v[176:179]
    v_perm_b32 v116, v38, v34, s58
    v_perm_b32 v117, v46, v42, s58
    v_perm_b32 v118, v54, v50, s58
    v_perm_b32 v119, v62, v58, s58
    v_mfma_f32_16x16x32_bf16 v[192:195], v[112:115], a[0:3], v[192:195]
    v_perm_b32 v120, v39, v35, s57
    v_perm_b32 v121, v47, v43, s57
    v_perm_b32 v122, v55, v51, s57
    v_perm_b32 v123, v63, v59, s57
    v_mfma_f32_16x16x32_bf16 v[208:211], v[116:119], a[0:3], v[208:211]
    v_perm_b32 v124, v39, v35, s58
    v_perm_b32 v125, v47, v43, s58
    v_perm_b32 v126, v55, v51, s58
    v_perm_b32 v127, v63, v59, s58
    v_mfma_f32_16x16x32_bf16 v[224:227], v[120:123], a[0:3], v[224:227]
    s_nop 0
    v_mfma_f32_16x16x32_bf16 v[240:243], v[124:127], a[0:3], v[240:243]
    v_mfma_f32_16x16x32_bf16 v[132:135], v[16:19], a[4:7], v[132:135]
    v_mfma_f32_16x16x32_bf16 v[148:151], v[100:103], a[4:7], v[148:151]
    v_mfma_f32_16x16x32_bf16 v[164:167], v[104:107], a[4:7], v[164:167]
    v_cvt_pk_bf16_f32 v32, v128, v144
    v_cvt_pk_bf16_f32 v33, v160, v176
    v_mfma_f32_16x16x32_bf16 v[180:183], v[108:111], a[4:7], v[180:183]
    v_cvt_pk_bf16_f32 v34, v192, v208
    s_nop 0
    v_cvt_pk_bf16_f32 v35, v224, v240
    v_mfma_f32_16x16x32_bf16 v[196:199], v[112:115], a[4:7], v[196:199]
    buffer_store_dwordx4 v[32:35], v8, s[20:23], s73 offen offset:0 sc1
    v_cvt_pk_bf16_f32 v36, v129, v145
    v_mfma_f32_16x16x32_bf16 v[212:215], v[116:119], a[4:7], v[212:215]
    v_cvt_pk_bf16_f32 v37, v161, v177
    v_cvt_pk_bf16_f32 v38, v193, v209
    v_mfma_f32_16x16x32_bf16 v[228:231], v[120:123], a[4:7], v[228:231]
    v_cvt_pk_bf16_f32 v39, v225, v241
    buffer_store_dwordx4 v[36:39], v8, s[20:23], s73 offen offset:1024 sc1
    v_mfma_f32_16x16x32_bf16 v[244:247], v[124:127], a[4:7], v[244:247]
    v_cvt_pk_bf16_f32 v40, v130, v146
    v_cvt_pk_bf16_f32 v41, v162, v178
    v_mfma_f32_16x16x32_bf16 v[136:139], v[16:19], a[8:11], v[136:139]
    v_cvt_pk_bf16_f32 v42, v194, v210
    v_cvt_pk_bf16_f32 v43, v226, v242
    v_mfma_f32_16x16x32_bf16 v[152:155], v[100:103], a[8:11], v[152:155]
    buffer_store_dwordx4 v[40:43], v8, s[20:23], s73 offen offset:2048 sc1
    v_cvt_pk_bf16_f32 v44, v131, v147
    v_mfma_f32_16x16x32_bf16 v[168:171], v[104:107], a[8:11], v[168:171]
    v_cvt_pk_bf16_f32 v45, v163, v179
    v_cvt_pk_bf16_f32 v46, v195, v211
    v_mfma_f32_16x16x32_bf16 v[184:187], v[108:111], a[8:11], v[184:187]
    v_cvt_pk_bf16_f32 v47, v227, v243
    buffer_store_dwordx4 v[44:47], v8, s[20:23], s73 offen offset:3072 sc1
    v_mfma_f32_16x16x32_bf16 v[200:203], v[112:115], a[8:11], v[200:203]
    v_cvt_pk_bf16_f32 v48, v132, v148
    v_cvt_pk_bf16_f32 v49, v164, v180
    v_mfma_f32_16x16x32_bf16 v[216:219], v[116:119], a[8:11], v[216:219]
    v_cvt_pk_bf16_f32 v50, v196, v212
    v_cvt_pk_bf16_f32 v51, v228, v244
    v_mfma_f32_16x16x32_bf16 v[232:235], v[120:123], a[8:11], v[232:235]
    buffer_store_dwordx4 v[48:51], v9, s[20:23], s74 offen offset:0 sc1
    v_cvt_pk_bf16_f32 v52, v133, v149
    v_mfma_f32_16x16x32_bf16 v[248:251], v[124:127], a[8:11], v[248:251]
    v_cvt_pk_bf16_f32 v53, v165, v181
    v_cvt_pk_bf16_f32 v54, v197, v213
    v_mfma_f32_16x16x32_bf16 v[140:143], v[16:19], a[12:15], v[140:143]
    v_cvt_pk_bf16_f32 v55, v229, v245
    buffer_store_dwordx4 v[52:55], v9, s[20:23], s74 offen offset:1024 sc1
    v_mfma_f32_16x16x32_bf16 v[156:159], v[100:103], a[12:15], v[156:159]
    v_cvt_pk_bf16_f32 v56, v134, v150
    v_cvt_pk_bf16_f32 v57, v166, v182
    v_mfma_f32_16x16x32_bf16 v[172:175], v[104:107], a[12:15], v[172:175]
    v_cvt_pk_bf16_f32 v58, v198, v214
    v_cvt_pk_bf16_f32 v59, v230, v246
    v_mfma_f32_16x16x32_bf16 v[188:191], v[108:111], a[12:15], v[188:191]
    buffer_store_dwordx4 v[56:59], v9, s[20:23], s74 offen offset:2048 sc1
    v_cvt_pk_bf16_f32 v60, v135, v151
    v_mfma_f32_16x16x32_bf16 v[204:207], v[112:115], a[12:15], v[204:207]
    v_cvt_pk_bf16_f32 v61, v167, v183
    v_cvt_pk_bf16_f32 v62, v199, v215
    v_mfma_f32_16x16x32_bf16 v[220:223], v[116:119], a[12:15], v[220:223]
    v_cvt_pk_bf16_f32 v63, v231, v247
    buffer_store_dwordx4 v[60:63], v9, s[20:23], s74 offen offset:3072 sc1
    v_mfma_f32_16x16x32_bf16 v[236:239], v[120:123], a[12:15], v[236:239]
    v_cvt_pk_bf16_f32 v64, v136, v152
    v_cvt_pk_bf16_f32 v65, v168, v184
    v_mfma_f32_16x16x32_bf16 v[252:255], v[124:127], a[12:15], v[252:255]
    v_cvt_pk_bf16_f32 v66, v200, v216
    v_cvt_pk_bf16_f32 v67, v232, v248
    buffer_store_dwordx4 v[64:67], v12, s[20:23], s75 offen offset:0 sc1
    v_cvt_pk_bf16_f32 v68, v137, v153
    v_cvt_pk_bf16_f32 v69, v169, v185
    v_cvt_pk_bf16_f32 v70, v201, v217
    v_cvt_pk_bf16_f32 v71, v233, v249
    buffer_store_dwordx4 v[68:71], v12, s[20:23], s75 offen offset:1024 sc1
    v_cvt_pk_bf16_f32 v72, v138, v154
    v_cvt_pk_bf16_f32 v73, v170, v186
    v_cvt_pk_bf16_f32 v74, v202, v218
    v_cvt_pk_bf16_f32 v75, v234, v250
    buffer_store_dwordx4 v[72:75], v12, s[20:23], s75 offen offset:2048 sc1
    v_cvt_pk_bf16_f32 v76, v139, v155
    v_cvt_pk_bf16_f32 v77, v171, v187
    v_cvt_pk_bf16_f32 v78, v203, v219
    v_cvt_pk_bf16_f32 v79, v235, v251
    buffer_store_dwordx4 v[76:79], v12, s[20:23], s75 offen offset:3072 sc1
    v_cvt_pk_bf16_f32 v80, v140, v156
    v_cvt_pk_bf16_f32 v81, v172, v188
    v_cvt_pk_bf16_f32 v82, v204, v220
    v_cvt_pk_bf16_f32 v83, v236, v252
    buffer_store_dwordx4 v[80:83], v14, s[20:23], s77 offen offset:0 sc1
    v_cvt_pk_bf16_f32 v84, v141, v157
    v_cvt_pk_bf16_f32 v85, v173, v189
    v_cvt_pk_bf16_f32 v86, v205, v221
    v_cvt_pk_bf16_f32 v87, v237, v253
    buffer_store_dwordx4 v[84:87], v14, s[20:23], s77 offen offset:1024 sc1
    v_cvt_pk_bf16_f32 v88, v142, v158
    v_cvt_pk_bf16_f32 v89, v174, v190
    v_cvt_pk_bf16_f32 v90, v206, v222
    v_cvt_pk_bf16_f32 v91, v238, v254
    buffer_store_dwordx4 v[88:91], v14, s[20:23], s77 offen offset:2048 sc1
    v_cvt_pk_bf16_f32 v92, v143, v159
    v_cvt_pk_bf16_f32 v93, v175, v191
    v_cvt_pk_bf16_f32 v94, v207, v223
    v_cvt_pk_bf16_f32 v95, v239, v255
    buffer_store_dwordx4 v[92:95], v14, s[20:23], s77 offen offset:3072 sc1
    s_and_b32 s68, s52, 1
    s_cmp_eq_u32 s68, 1
    s_mov_b32 s66, 0x00ff00ff
    s_mov_b32 s67, 0xff00ff00
    s_cselect_b32 s66, s67, s66
    s_mov_b32 s67, s66
    s_cmp_eq_u32 s76, 0
    s_cbranch_scc0 L_nolds0
    s_mov_b64 exec, s[66:67]
    ds_write_b128 v13, v[32:35] offset:0
    ds_write_b128 v13, v[36:39] offset:16
    ds_write_b128 v13, v[40:43] offset:32
    ds_write_b128 v13, v[44:47] offset:48
    s_mov_b64 exec, -1
L_nolds0:
    s_cmp_eq_u32 s76, 1
    s_cbranch_scc0 L_nolds1
    s_mov_b64 exec, s[66:67]
    ds_write_b128 v13, v[48:51] offset:0
    ds_write_b128 v13, v[52:55] offset:16
    ds_write_b128 v13, v[56:59] offset:32
    ds_write_b128 v13, v[60:63] offset:48
    s_mov_b64 exec, -1
L_nolds1:
    s_cmp_eq_u32 s76, 2
    s_cbranch_scc0 L_nolds2
    s_mov_b64 exec, s[66:67]
    ds_write_b128 v13, v[64:67] offset:0
    ds_write_b128 v13, v[68:71] offset:16
    ds_write_b128 v13, v[72:75] offset:32
    ds_write_b128 v13, v[76:79] offset:48
    s_mov_b64 exec, -1
L_nolds2:
    s_cmp_eq_u32 s76, 3
    s_cbranch_scc0 L_nolds3
    s_mov_b64 exec, s[66:67]
    ds_write_b128 v13, v[80:83] offset:0
    ds_write_b128 v13, v[84:87] offset:16
    ds_write_b128 v13, v[88:91] offset:32
    ds_write_b128 v13, v[92:95] offset:48
    s_mov_b64 exec, -1
L_nolds3:
    s_load_dwordx2 s[24:25], s[0:1], 80
    v_and_b32 v12, 7, v0
    v_lshrrev_b32 v13, 3, v0
    s_lshl_b32 s74, s52, 3
    s_add_u32 s74, s74, s55
    v_add_u32 v14, s74, v12
    v_lshlrev_b32 v14, 10, v14
    v_lshlrev_b32 v126, 4, v13
    v_add_u32 v126, v126, v14
    v_lshlrev_b32 v14, 4, v12
    v_add_u32 v14, 67328, v14
    ds_read_b96 v[120:122], v14
    buffer_load_dwordx4 v[96:99], v126, s[8:11], 0 offen
    buffer_load_dwordx4 v[100:103], v126, s[8:11], 0 offen offset:512
    s_lshl_b32 s75, s53, 16
    s_lshr_b32 s76, s52, 1
    s_lshl_b32 s76, s76, 12
    s_add_u32 s75, s75, s76
    s_and_b32 s76, s52, 1
    s_lshl_b32 s76, s76, 7
    s_add_u32 s75, s75, s76
    v_lshrrev_b32 v14, 4, v13
    v_lshlrev_b32 v124, 14, v14
    v_and_b32 v14, 3, v13
    v_lshlrev_b32 v14, 10, v14
    v_add_u32 v124, v124, v14
    v_bfe_u32 v14, v13, 2, 2
    v_lshlrev_b32 v14, 8, v14
    v_add_u32 v124, v124, v14
    v_lshlrev_b32 v14, 4, v12
    v_add_u32 v124, v124, v14
    v_add_u32 v124, s75, v124
    v_add_u32 v125, 32768, v124
    v_mul_u32_u24 v127, 1040, v12
    v_lshlrev_b32 v14, 4, v13
    v_add_u32 v127, v127, v14
    v_add_u32 v127, 67840, v127
    s_waitcnt lgkmcnt(0)
    s_mov_b32 s26, 2097152
    s_mov_b32 s27, 0x20000
    s_cmp_lg_u32 s56, 7
    s_cbranch_scc0 L_noffn
    v_accvgpr_read_b32 v192, a216
    v_accvgpr_read_b32 v193, a217
    v_accvgpr_read_b32 v194, a218
    v_accvgpr_read_b32 v195, a219
    v_accvgpr_read_b32 v196, a220
    v_lshlrev_b32 v198, 16, v192
    v_and_b32 v199, s63, v192
    v_lshlrev_b32 v200, 16, v193
    v_and_b32 v201, s63, v193
    v_lshlrev_b32 v202, 16, v194
    v_and_b32 v203, s63, v194
    v_lshlrev_b32 v204, 16, v195
    v_and_b32 v205, s63, v195
    v_pk_add_f32 v[208:209], v[198:199], v[200:201]
    v_pk_add_f32 v[210:211], v[202:203], v[204:205]
    v_pk_add_f32 v[208:209], v[208:209], v[210:211]
    v_add_f32 v206, v208, v209
    s_nop 1
    v_add_f32_dpp v206, v206, v206 quad_perm:[1,0,3,2] row_mask:0xf bank_mask:0xf
    s_nop 1
    v_add_f32_dpp v206, v206, v206 quad_perm:[2,3,0,1] row_mask:0xf bank_mask:0xf
    s_nop 1
    v_add_f32_dpp v206, v206, v206 row_half_mirror row_mask:0xf bank_mask:0xf
    s_nop 1
    v_add_f32_dpp v206, v206, v206 row_mirror row_mask:0xf bank_mask:0xf
    v_mov_b32 v207, v206
    s_nop 1
    v_permlane16_swap_b32 v206, v207
    v_add_f32 v206, v206, v207
    v_mov_b32 v207, v206
    s_nop 1
    v_permlane32_swap_b32 v206, v207
    v_add_f32 v206, v206, v207
    v_mul_f32 v206, 0x3b000000, v206
    v_pk_add_f32 v[198:199], v[198:199], v[206:207] op_sel_hi:[1,0] neg_lo:[0,1] neg_hi:[0,1]
    v_pk_add_f32 v[200:201], v[200:201], v[206:207] op_sel_hi:[1,0] neg_lo:[0,1] neg_hi:[0,1]
    v_pk_add_f32 v[202:203], v[202:203], v[206:207] op_sel_hi:[1,0] neg_lo:[0,1] neg_hi:[0,1]
    v_pk_add_f32 v[204:205], v[204:205], v[206:207] op_sel_hi:[1,0] neg_lo:[0,1] neg_hi:[0,1]
    v_pk_mul_f32 v[208:209], v[198:199], v[198:199]
    v_pk_fma_f32 v[208:209], v[200:201], v[200:201], v[208:209]
    v_pk_fma_f32 v[208:209], v[202:203], v[202:203], v[208:209]
    v_pk_fma_f32 v[208:209], v[204:205], v[204:205], v[208:209]
    v_add_f32 v208, v208, v209
    s_nop 1
    v_add_f32_dpp v208, v208, v208 quad_perm:[1,0,3,2] row_mask:0xf bank_mask:0xf
    s_nop 1
    v_add_f32_dpp v208, v208, v208 quad_perm:[2,3,0,1] row_mask:0xf bank_mask:0xf
    s_nop 1
    v_add_f32_dpp v208, v208, v208 row_half_mirror row_mask:0xf bank_mask:0xf
    s_nop 1
    v_add_f32_dpp v208, v208, v208 row_mirror row_mask:0xf bank_mask:0xf
    v_mov_b32 v207, v208
    s_nop 1
    v_permlane16_swap_b32 v208, v207
    v_add_f32 v208, v208, v207
    v_mov_b32 v207, v208
    s_nop 1
    v_permlane32_swap_b32 v208, v207
    v_add_f32 v208, v208, v207
    v_mul_f32 v208, 0x3b000000, v208
    v_cvt_pk_bf16_f32 v209, v206, v208
    v_lshlrev_b32 v210, 16, v209
    v_and_b32 v209, s63, v209
    v_add_f32 v209, 0x3727c5ac, v209
    v_cvt_pk_bf16_f32 v209, v209, v209
    v_and_b32 v209, s63, v209
    v_sqrt_f32 v209, v209
    v_sub_f32 v210, v206, v210
    v_cvt_pk_bf16_f32 v209, v209, v209
    v_and_b32 v209, s63, v209
    v_rcp_f32 v208, v209
    s_nop 0
    v_mul_f32 v210, v210, v208
    v_lshlrev_b32 v198, 16, v196
    v_and_b32 v199, s63, v196
    v_pk_add_f32 v[198:199], v[198:199], v[206:207] op_sel_hi:[1,0] neg_lo:[0,1] neg_hi:[0,1]
    v_pk_fma_f32 v[198:199], v[198:199], v[208:209], v[210:211] op_sel_hi:[1,0,0]
    v_cvt_pk_bf16_f32 v192, v198, v199
    v_accvgpr_read_b32 v216, a192
    v_accvgpr_read_b32 v217, a193
    v_accvgpr_read_b32 v218, a194
    v_accvgpr_read_b32 v219, a195
    v_accvgpr_read_b32 v220, a196
    v_accvgpr_read_b32 v221, a197
    v_accvgpr_read_b32 v222, a198
    v_accvgpr_read_b32 v223, a199
    v_accvgpr_read_b32 v224, a200
    v_accvgpr_read_b32 v225, a201
    v_accvgpr_read_b32 v226, a202
    v_accvgpr_read_b32 v227, a203
    v_accvgpr_read_b32 v228, a204
    v_accvgpr_read_b32 v229, a205
    v_accvgpr_read_b32 v230, a206
    v_accvgpr_read_b32 v231, a207
    v_perm_b32 v194, v220, v216, s57
    v_dot2_f32_bf16 v232, v194, v192, 0
    v_perm_b32 v195, v220, v216, s58
    v_dot2_f32_bf16 v233, v195, v192, 0
    v_perm_b32 v196, v221, v217, s57
    v_dot2_f32_bf16 v234, v196, v192, 0
    v_perm_b32 v197, v221, v217, s58
    v_dot2_f32_bf16 v235, v197, v192, 0
    v_perm_b32 v194, v222, v218, s57
    v_dot2_f32_bf16 v236, v194, v192, 0
    v_perm_b32 v195, v222, v218, s58
    v_dot2_f32_bf16 v237, v195, v192, 0
    v_perm_b32 v196, v223, v219, s57
    v_dot2_f32_bf16 v238, v196, v192, 0
    v_perm_b32 v197, v223, v219, s58
    v_dot2_f32_bf16 v239, v197, v192, 0
    v_perm_b32 v194, v228, v224, s57
    v_dot2_f32_bf16 v240, v194, v192, 0
    v_perm_b32 v195, v228, v224, s58
    v_dot2_f32_bf16 v241, v195, v192, 0
    v_perm_b32 v196, v229, v225, s57
    v_dot2_f32_bf16 v242, v196, v192, 0
    v_perm_b32 v197, v229, v225, s58
    v_dot2_f32_bf16 v243, v197, v192, 0
    v_perm_b32 v194, v230, v226, s57
    v_dot2_f32_bf16 v244, v194, v192, 0
    v_perm_b32 v195, v230, v226, s58
    v_dot2_f32_bf16 v245, v195, v192, 0
    v_perm_b32 v196, v231, v227, s57
    v_dot2_f32_bf16 v246, v196, v192, 0
    v_perm_b32 v197, v231, v227, s58
    v_dot2_f32_bf16 v247, v197, v192, 0
    s_nop 2
    v_permlane32_swap_b32 v232, v240
    v_permlane32_swap_b32 v233, v241
    v_permlane32_swap_b32 v234, v242
    v_permlane32_swap_b32 v235, v243
    v_permlane32_swap_b32 v236, v244
    v_permlane32_swap_b32 v237, v245
    v_permlane32_swap_b32 v238, v246
    v_permlane32_swap_b32 v239, v247
    v_add_f32 v232, v232, v240
    v_add_f32 v233, v233, v241
    v_add_f32 v234, v234, v242
    v_add_f32 v235, v235, v243
    v_add_f32 v236, v236, v244
    v_add_f32 v237, v237, v245
    v_add_f32 v238, v238, v246
    v_add_f32 v239, v239, v247
    v_permlane16_swap_b32 v232, v236
    v_permlane16_swap_b32 v233, v237
    v_permlane16_swap_b32 v234, v238
    v_permlane16_swap_b32 v235, v239
    v_add_f32 v232, v232, v236
    v_add_f32 v233, v233, v237
    v_add_f32 v234, v234, v238
    v_add_f32 v235, v235, v239
    v_add_f32_dpp v232, v232, v232 quad_perm:[1,0,3,2] row_mask:0xf bank_mask:0xf
    v_add_f32_dpp v233, v233, v233 quad_perm:[1,0,3,2] row_mask:0xf bank_mask:0xf
    v_add_f32_dpp v234, v234, v234 quad_perm:[1,0,3,2] row_mask:0xf bank_mask:0xf
    v_add_f32_dpp v235, v235, v235 quad_perm:[1,0,3,2] row_mask:0xf bank_mask:0xf
    v_add_f32_dpp v232, v232, v232 quad_perm:[2,3,0,1] row_mask:0xf bank_mask:0xf
    v_add_f32_dpp v233, v233, v233 quad_perm:[2,3,0,1] row_mask:0xf bank_mask:0xf
    v_add_f32_dpp v234, v234, v234 quad_perm:[2,3,0,1] row_mask:0xf bank_mask:0xf
    v_add_f32_dpp v235, v235, v235 quad_perm:[2,3,0,1] row_mask:0xf bank_mask:0xf
    v_add_f32_dpp v232, v232, v232 row_half_mirror row_mask:0xf bank_mask:0xf
    v_add_f32_dpp v233, v233, v233 row_half_mirror row_mask:0xf bank_mask:0xf
    v_add_f32_dpp v234, v234, v234 row_half_mirror row_mask:0xf bank_mask:0xf
    v_add_f32_dpp v235, v235, v235 row_half_mirror row_mask:0xf bank_mask:0xf
    v_add_f32_dpp v232, v232, v232 row_mirror row_mask:0xf bank_mask:0xf
    v_add_f32_dpp v233, v233, v233 row_mirror row_mask:0xf bank_mask:0xf
    v_add_f32_dpp v234, v234, v234 row_mirror row_mask:0xf bank_mask:0xf
    v_add_f32_dpp v235, v235, v235 row_mirror row_mask:0xf bank_mask:0xf
    v_lshrrev_b32 v194, 4, v1
    v_lshlrev_b32 v194, 4, v194
    s_lshl_b32 s73, s54, 6
    s_add_u32 s73, s73, 66880
    v_add_u32 v194, s73, v194
    ds_write_b128 v194, v[232:235]
    s_waitcnt lgkmcnt(0)
    s_barrier
    v_and_b32 v192, 15, v1
    v_lshlrev_b32 v192, 2, v192
    v_add_u32 v192, 66880, v192
    ds_read_b32 v193, v192
    ds_read_b32 v194, v192 offset:64
    ds_read_b32 v195, v192 offset:128
    ds_read_b32 v196, v192 offset:192
    v_accvgpr_read_b32 v208, a208
    v_accvgpr_read_b32 v209, a209
    v_accvgpr_read_b32 v210, a210
    v_accvgpr_read_b32 v211, a211
    v_accvgpr_read_b32 v212, a212
    v_accvgpr_read_b32 v213, a213
    v_accvgpr_read_b32 v214, a214
    v_accvgpr_read_b32 v215, a215
    s_waitcnt lgkmcnt(0)
    v_add_f32 v193, v193, v194
    v_add_f32 v195, v195, v196
    v_add_f32 v193, v193, v195
    v_cvt_pk_bf16_f32 v193, v193, v193
    v_and_b32 v193, s63, v193
    v_mul_f32 v194, 0xbfb8aa3b, v193
    v_exp_f32 v194, v194
    s_nop 0
    v_add_f32 v194, 1.0, v194
    v_rcp_f32 v194, v194
    s_nop 0
    v_mul_f32 v194, v193, v194
    v_cvt_pk_bf16_f32 v194, v194, v194
    v_and_b32 v194, s63, v194
    v_mov_b32_dpp v195, v193 row_ror:8 row_mask:0xf bank_mask:0xf
    v_mul_f32 v194, v194, v195
    v_cvt_pk_bf16_f32 v194, v194, v194
    v_and_b32 v194, s63, v194
    s_nop 0
    v_readlane_b32 s64, v194, 0
    v_readlane_b32 s65, v194, 1
    v_readlane_b32 s66, v194, 2
    v_readlane_b32 s67, v194, 3
    v_readlane_b32 s68, v194, 4
    v_readlane_b32 s69, v194, 5
    v_readlane_b32 s70, v194, 6
    v_readlane_b32 s71, v194, 7
    v_mov_b32 v8, 0
    v_mov_b32 v9, 0
    v_lshlrev_b32 v196, 16, v208
    v_and_b32 v197, s63, v208
    v_fmac_f32 v8, s64, v196
    v_fmac_f32 v9, s64, v197
    v_lshlrev_b32 v196, 16, v209
    v_and_b32 v197, s63, v209
    v_fmac_f32 v8, s65, v196
    v_fmac_f32 v9, s65, v197
    v_lshlrev_b32 v196, 16, v210
    v_and_b32 v197, s63, v210
    v_fmac_f32 v8, s66, v196
    v_fmac_f32 v9, s66, v197
    v_lshlrev_b32 v196, 16, v211
    v_and_b32 v197, s63, v211
    v_fmac_f32 v8, s67, v196
    v_fmac_f32 v9, s67, v197
    v_lshlrev_b32 v196, 16, v212
    v_and_b32 v197, s63, v212
    v_fmac_f32 v8, s68, v196
    v_fmac_f32 v9, s68, v197
    v_lshlrev_b32 v196, 16, v213
    v_and_b32 v197, s63, v213
    v_fmac_f32 v8, s69, v196
    v_fmac_f32 v9, s69, v197
    v_lshlrev_b32 v196, 16, v214
    v_and_b32 v197, s63, v214
    v_fmac_f32 v8, s70, v196
    v_fmac_f32 v9, s70, v197
    v_lshlrev_b32 v196, 16, v215
    v_and_b32 v197, s63, v215
    v_fmac_f32 v8, s71, v196
    v_fmac_f32 v9, s71, v197
    v_lshlrev_b32 v10, 3, v0
    s_lshl_b32 s73, s52, 11
    s_add_u32 s73, s73, 18874368
    buffer_atomic_add_f32 v8, v10, s[20:23], s73 offen offset:0
    buffer_atomic_add_f32 v9, v10, s[20:23], s73 offen offset:4
L_noffn:
    v_and_b32 v12, 7, v1
    v_lshlrev_b32 v12, 2, v12
    s_lshl_b32 s75, s53, 7
    s_add_u32 s75, s75, 18898944
    v_add_u32 v12, s75, v12
    buffer_load_dword v11, v12, s[20:23], 0 offen sc1
    s_waitcnt vmcnt(0) lgkmcnt(0)
    s_barrier
    s_lshl_b32 s77, s53, 3
    s_add_u32 s77, s77, s52
    s_cmp_eq_u32 s54, 0
    s_cbranch_scc0 L_noflag
    s_lshl_b32 s74, s53, 7
    s_lshl_b32 s75, s52, 2
    s_add_u32 s74, s74, s75
    s_add_u32 s74, s74, 18898944
    v_mov_b32 v12, s74
    v_mov_b32 v13, s83
    s_mov_b64 exec, 1
    buffer_store_dword v13, v12, s[20:23], 0 offen sc1
    s_mov_b64 exec, -1
L_noflag:
    v_cmp_eq_u32 vcc, s83, v11
    s_lshl_b32 s68, 1, s52
    s_nop 3
    s_and_b32 s72, vcc_lo, 0xff
    s_andn2_b32 s72, s72, s68
    s_bitcmp1_b32 s72, 0
    s_cbranch_scc0 L_eskip0
    s_mov_b32 s74, 0
    buffer_load_dwordx4 v[128:131], v124, s[20:23], s74 offen sc1
    buffer_load_dwordx4 v[132:135], v125, s[20:23], s74 offen sc1
L_eskip0:
    s_bitcmp1_b32 s72, 1
    s_cbranch_scc0 L_eskip1
    s_mov_b32 s74, 2097152
    buffer_load_dwordx4 v[136:139], v124, s[20:23], s74 offen sc1
    buffer_load_dwordx4 v[140:143], v125, s[20:23], s74 offen sc1
L_eskip1:
    s_bitcmp1_b32 s72, 2
    s_cbranch_scc0 L_eskip2
    s_mov_b32 s74, 4194304
    buffer_load_dwordx4 v[144:147], v124, s[20:23], s74 offen sc1
    buffer_load_dwordx4 v[148:151], v125, s[20:23], s74 offen sc1
L_eskip2:
    s_bitcmp1_b32 s72, 3
    s_cbranch_scc0 L_eskip3
    s_mov_b32 s74, 6291456
    buffer_load_dwordx4 v[152:155], v124, s[20:23], s74 offen sc1
    buffer_load_dwordx4 v[156:159], v125, s[20:23], s74 offen sc1
L_eskip3:
    s_bitcmp1_b32 s72, 4
    s_cbranch_scc0 L_eskip4
    s_mov_b32 s74, 8388608
    buffer_load_dwordx4 v[160:163], v124, s[20:23], s74 offen sc1
    buffer_load_dwordx4 v[164:167], v125, s[20:23], s74 offen sc1
L_eskip4:
    s_bitcmp1_b32 s72, 5
    s_cbranch_scc0 L_eskip5
    s_mov_b32 s74, 10485760
    buffer_load_dwordx4 v[168:171], v124, s[20:23], s74 offen sc1
    buffer_load_dwordx4 v[172:175], v125, s[20:23], s74 offen sc1
L_eskip5:
    s_bitcmp1_b32 s72, 6
    s_cbranch_scc0 L_eskip6
    s_mov_b32 s74, 12582912
    buffer_load_dwordx4 v[176:179], v124, s[20:23], s74 offen sc1
    buffer_load_dwordx4 v[180:183], v125, s[20:23], s74 offen sc1
L_eskip6:
    s_bitcmp1_b32 s72, 7
    s_cbranch_scc0 L_eskip7
    s_mov_b32 s74, 14680064
    buffer_load_dwordx4 v[184:187], v124, s[20:23], s74 offen sc1
    buffer_load_dwordx4 v[188:191], v125, s[20:23], s74 offen sc1
L_eskip7:
    v_lshlrev_b32 v213, 16, v96
    v_and_b32 v214, s63, v96
    v_sub_f32 v209, v213, v120
    v_sub_f32 v210, v214, v120
    v_fma_f32 v209, v209, v121, v122
    v_fma_f32 v210, v210, v121, v122
    v_cvt_pk_bf16_f32 v208, v209, v210
    v_lshlrev_b32 v209, 16, v208
    v_and_b32 v210, s63, v208
    v_mul_f32 v211, 0xbfb8aa3b, v209
    v_mul_f32 v212, 0xbfb8aa3b, v210
    v_exp_f32 v211, v211
    v_exp_f32 v212, v212
    s_nop 0
    v_add_f32 v211, 1.0, v211
    v_add_f32 v212, 1.0, v212
    v_rcp_f32 v211, v211
    v_rcp_f32 v212, v212
    s_nop 0
    v_mul_f32 v211, v209, v211
    v_mul_f32 v212, v210, v212
    v_cvt_pk_bf16_f32 v232, v211, v212
    v_lshlrev_b32 v221, 16, v97
    v_and_b32 v222, s63, v97
    v_sub_f32 v217, v221, v120
    v_sub_f32 v218, v222, v120
    v_fma_f32 v217, v217, v121, v122
    v_fma_f32 v218, v218, v121, v122
    v_cvt_pk_bf16_f32 v216, v217, v218
    v_lshlrev_b32 v217, 16, v216
    v_and_b32 v218, s63, v216
    v_mul_f32 v219, 0xbfb8aa3b, v217
    v_mul_f32 v220, 0xbfb8aa3b, v218
    v_exp_f32 v219, v219
    v_exp_f32 v220, v220
    s_nop 0
    v_add_f32 v219, 1.0, v219
    v_add_f32 v220, 1.0, v220
    v_rcp_f32 v219, v219
    v_rcp_f32 v220, v220
    s_nop 0
    v_mul_f32 v219, v217, v219
    v_mul_f32 v220, v218, v220
    v_cvt_pk_bf16_f32 v233, v219, v220
    v_lshlrev_b32 v213, 16, v98
    v_and_b32 v214, s63, v98
    v_sub_f32 v209, v213, v120
    v_sub_f32 v210, v214, v120
    v_fma_f32 v209, v209, v121, v122
    v_fma_f32 v210, v210, v121, v122
    v_cvt_pk_bf16_f32 v208, v209, v210
    v_lshlrev_b32 v209, 16, v208
    v_and_b32 v210, s63, v208
    v_mul_f32 v211, 0xbfb8aa3b, v209
    v_mul_f32 v212, 0xbfb8aa3b, v210
    v_exp_f32 v211, v211
    v_exp_f32 v212, v212
    s_nop 0
    v_add_f32 v211, 1.0, v211
    v_add_f32 v212, 1.0, v212
    v_rcp_f32 v211, v211
    v_rcp_f32 v212, v212
    s_nop 0
    v_mul_f32 v211, v209, v211
    v_mul_f32 v212, v210, v212
    v_cvt_pk_bf16_f32 v234, v211, v212
    v_lshlrev_b32 v221, 16, v99
    v_and_b32 v222, s63, v99
    v_sub_f32 v217, v221, v120
    v_sub_f32 v218, v222, v120
    v_fma_f32 v217, v217, v121, v122
    v_fma_f32 v218, v218, v121, v122
    v_cvt_pk_bf16_f32 v216, v217, v218
    v_lshlrev_b32 v217, 16, v216
    v_and_b32 v218, s63, v216
    v_mul_f32 v219, 0xbfb8aa3b, v217
    v_mul_f32 v220, 0xbfb8aa3b, v218
    v_exp_f32 v219, v219
    v_exp_f32 v220, v220
    s_nop 0
    v_add_f32 v219, 1.0, v219
    v_add_f32 v220, 1.0, v220
    v_rcp_f32 v219, v219
    v_rcp_f32 v220, v220
    s_nop 0
    v_mul_f32 v219, v217, v219
    v_mul_f32 v220, v218, v220
    v_cvt_pk_bf16_f32 v235, v219, v220
    v_lshlrev_b32 v213, 16, v100
    v_and_b32 v214, s63, v100
    v_sub_f32 v209, v213, v120
    v_sub_f32 v210, v214, v120
    v_fma_f32 v209, v209, v121, v122
    v_fma_f32 v210, v210, v121, v122
    v_cvt_pk_bf16_f32 v208, v209, v210
    v_lshlrev_b32 v209, 16, v208
    v_and_b32 v210, s63, v208
    v_mul_f32 v211, 0xbfb8aa3b, v209
    v_mul_f32 v212, 0xbfb8aa3b, v210
    v_exp_f32 v211, v211
    v_exp_f32 v212, v212
    s_nop 0
    v_add_f32 v211, 1.0, v211
    v_add_f32 v212, 1.0, v212
    v_rcp_f32 v211, v211
    v_rcp_f32 v212, v212
    s_nop 0
    v_mul_f32 v211, v209, v211
    v_mul_f32 v212, v210, v212
    v_cvt_pk_bf16_f32 v236, v211, v212
    v_lshlrev_b32 v221, 16, v101
    v_and_b32 v222, s63, v101
    v_sub_f32 v217, v221, v120
    v_sub_f32 v218, v222, v120
    v_fma_f32 v217, v217, v121, v122
    v_fma_f32 v218, v218, v121, v122
    v_cvt_pk_bf16_f32 v216, v217, v218
    v_lshlrev_b32 v217, 16, v216
    v_and_b32 v218, s63, v216
    v_mul_f32 v219, 0xbfb8aa3b, v217
    v_mul_f32 v220, 0xbfb8aa3b, v218
    v_exp_f32 v219, v219
    v_exp_f32 v220, v220
    s_nop 0
    v_add_f32 v219, 1.0, v219
    v_add_f32 v220, 1.0, v220
    v_rcp_f32 v219, v219
    v_rcp_f32 v220, v220
    s_nop 0
    v_mul_f32 v219, v217, v219
    v_mul_f32 v220, v218, v220
    v_cvt_pk_bf16_f32 v237, v219, v220
    v_lshlrev_b32 v213, 16, v102
    v_and_b32 v214, s63, v102
    v_sub_f32 v209, v213, v120
    v_sub_f32 v210, v214, v120
    v_fma_f32 v209, v209, v121, v122
    v_fma_f32 v210, v210, v121, v122
    v_cvt_pk_bf16_f32 v208, v209, v210
    v_lshlrev_b32 v209, 16, v208
    v_and_b32 v210, s63, v208
    v_mul_f32 v211, 0xbfb8aa3b, v209
    v_mul_f32 v212, 0xbfb8aa3b, v210
    v_exp_f32 v211, v211
    v_exp_f32 v212, v212
    s_nop 0
    v_add_f32 v211, 1.0, v211
    v_add_f32 v212, 1.0, v212
    v_rcp_f32 v211, v211
    v_rcp_f32 v212, v212
    s_nop 0
    v_mul_f32 v211, v209, v211
    v_mul_f32 v212, v210, v212
    v_cvt_pk_bf16_f32 v238, v211, v212
    v_lshlrev_b32 v221, 16, v103
    v_and_b32 v222, s63, v103
    v_sub_f32 v217, v221, v120
    v_sub_f32 v218, v222, v120
    v_fma_f32 v217, v217, v121, v122
    v_fma_f32 v218, v218, v121, v122
    v_cvt_pk_bf16_f32 v216, v217, v218
    v_lshlrev_b32 v217, 16, v216
    v_and_b32 v218, s63, v216
    v_mul_f32 v219, 0xbfb8aa3b, v217
    v_mul_f32 v220, 0xbfb8aa3b, v218
    v_exp_f32 v219, v219
    v_exp_f32 v220, v220
    s_nop 0
    v_add_f32 v219, 1.0, v219
    v_add_f32 v220, 1.0, v220
    v_rcp_f32 v219, v219
    v_rcp_f32 v220, v220
    s_nop 0
    v_mul_f32 v219, v217, v219
    v_mul_f32 v220, v218, v220
    v_cvt_pk_bf16_f32 v239, v219, v220
    s_lshr_b32 s74, s79, 3
    s_cmp_eq_u32 s74, s77
    s_cselect_b32 s78, 1, 0
    v_lshrrev_b32 v13, 10, v126
    v_mov_b32 v14, 0x7ffffff0
    v_cmp_eq_u32 vcc, s79, v13
    v_and_b32 v13, 7, v1
    v_lshlrev_b32 v12, 2, v13
    v_cndmask_b32 v123, v126, v14, vcc
    s_lshl_b32 s75, s53, 7
    s_add_u32 s75, s75, 18898944
    v_add_u32 v12, s75, v12
    v_lshrrev_b32 v14, 1, v1
    v_lshlrev_b32 v14, 7, v14
    v_and_b32 v11, 1, v1
    v_lshlrev_b32 v11, 4, v11
    v_add_u32 v14, v14, v11
    v_add_u32 v14, 18898944, v14
    s_lshl_b32 s66, 1, s52
    s_or_b32 s66, s66, s72
    s_mov_b32 s67, s72
    s_mov_b32 s76, 0
    s_mov_b32 s69, 0
    s_cmp_eq_u32 s66, 0xff
    s_mov_b32 s70, 0
    s_cbranch_scc1 L_pollgot
L_pentry:
L_fpoll:
    buffer_load_dword v13, v12, s[20:23], 0 offen sc1
    s_cmp_eq_u32 s78, 1
    s_cbranch_scc0 L_noall1
    buffer_load_dwordx4 v[192:195], v14, s[20:23], 0 offen sc1
L_noall1:
    s_waitcnt vmcnt(0)
    v_cmp_eq_u32 vcc, s83, v13
    s_nop 4
    s_and_b32 s69, vcc_lo, 0xff
    s_cmp_eq_u32 s78, 1
    s_cbranch_scc0 L_pollgot
    v_xor_b32 v192, s83, v192
    v_xor_b32 v193, s83, v193
    v_xor_b32 v194, s83, v194
    v_xor_b32 v195, s83, v195
    v_or_b32 v192, v192, v193
    v_or3_b32 v192, v192, v194, v195
    v_cmp_ne_u32 vcc, 0, v192
    s_nop 4
    s_cmp_eq_u64 vcc, 0
    s_cselect_b32 s74, 1, 0
    s_andn2_b32 s74, s74, s70
    s_cmp_eq_u32 s74, 1
    s_cbranch_scc0 L_noya
    s_mov_b32 s70, 1
    v_lshlrev_b32 v11, 3, v0
    s_mov_b32 s75, 18874368
    buffer_load_dwordx2 v[72:73], v11, s[20:23], s75 offen offset:0 sc1
    buffer_load_dwordx2 v[74:75], v11, s[20:23], s75 offen offset:2048 sc1
    s_add_u32 s75, s75, 4096
    buffer_load_dwordx2 v[76:77], v11, s[20:23], s75 offen offset:0 sc1
    buffer_load_dwordx2 v[78:79], v11, s[20:23], s75 offen offset:2048 sc1
    s_add_u32 s75, s75, 4096
    buffer_load_dwordx2 v[80:81], v11, s[20:23], s75 offen offset:0 sc1
    buffer_load_dwordx2 v[82:83], v11, s[20:23], s75 offen offset:2048 sc1
    s_add_u32 s75, s75, 4096
    buffer_load_dwordx2 v[84:85], v11, s[20:23], s75 offen offset:0 sc1
    buffer_load_dwordx2 v[86:87], v11, s[20:23], s75 offen offset:2048 sc1
L_noya:
L_pollgot:
    s_add_u32 s76, s76, 1
    s_or_b32 s66, s66, s69
    s_andn2_b32 s68, s66, s67
    s_bitcmp1_b32 s68, 0
    s_cbranch_scc0 L_skip0
    s_cmp_eq_u32 s52, 0
    s_cbranch_scc0 L_glob0
    ds_read_b128 v[128:131], v127
    ds_read_b128 v[132:135], v127 offset:512
    s_branch L_skip0
L_glob0:
    s_mov_b32 s74, 0
    s_waitcnt lgkmcnt(1)
    buffer_load_dwordx4 v[128:131], v124, s[20:23], s74 offen sc1
    s_waitcnt lgkmcnt(0)
    buffer_load_dwordx4 v[132:135], v125, s[20:23], s74 offen sc1
L_skip0:
    s_bitcmp1_b32 s68, 1
    s_cbranch_scc0 L_skip1
    s_cmp_eq_u32 s52, 1
    s_cbranch_scc0 L_glob1
    ds_read_b128 v[136:139], v127
    ds_read_b128 v[140:143], v127 offset:512
    s_branch L_skip1
L_glob1:
    s_mov_b32 s74, 2097152
    s_waitcnt lgkmcnt(1)
    buffer_load_dwordx4 v[136:139], v124, s[20:23], s74 offen sc1
    s_waitcnt lgkmcnt(0)
    buffer_load_dwordx4 v[140:143], v125, s[20:23], s74 offen sc1
L_skip1:
    s_bitcmp1_b32 s68, 2
    s_cbranch_scc0 L_skip2
    s_cmp_eq_u32 s52, 2
    s_cbranch_scc0 L_glob2
    ds_read_b128 v[144:147], v127
    ds_read_b128 v[148:151], v127 offset:512
    s_branch L_skip2
L_glob2:
    s_mov_b32 s74, 4194304
    s_waitcnt lgkmcnt(1)
    buffer_load_dwordx4 v[144:147], v124, s[20:23], s74 offen sc1
    s_waitcnt lgkmcnt(0)
    buffer_load_dwordx4 v[148:151], v125, s[20:23], s74 offen sc1
L_skip2:
    s_bitcmp1_b32 s68, 3
    s_cbranch_scc0 L_skip3
    s_cmp_eq_u32 s52, 3
    s_cbranch_scc0 L_glob3
    ds_read_b128 v[152:155], v127
    ds_read_b128 v[156:159], v127 offset:512
    s_branch L_skip3
L_glob3:
    s_mov_b32 s74, 6291456
    s_waitcnt lgkmcnt(1)
    buffer_load_dwordx4 v[152:155], v124, s[20:23], s74 offen sc1
    s_waitcnt lgkmcnt(0)
    buffer_load_dwordx4 v[156:159], v125, s[20:23], s74 offen sc1
L_skip3:
    s_bitcmp1_b32 s68, 4
    s_cbranch_scc0 L_skip4
    s_cmp_eq_u32 s52, 4
    s_cbranch_scc0 L_glob4
    ds_read_b128 v[160:163], v127
    ds_read_b128 v[164:167], v127 offset:512
    s_branch L_skip4
L_glob4:
    s_mov_b32 s74, 8388608
    s_waitcnt lgkmcnt(1)
    buffer_load_dwordx4 v[160:163], v124, s[20:23], s74 offen sc1
    s_waitcnt lgkmcnt(0)
    buffer_load_dwordx4 v[164:167], v125, s[20:23], s74 offen sc1
L_skip4:
    s_bitcmp1_b32 s68, 5
    s_cbranch_scc0 L_skip5
    s_cmp_eq_u32 s52, 5
    s_cbranch_scc0 L_glob5
    ds_read_b128 v[168:171], v127
    ds_read_b128 v[172:175], v127 offset:512
    s_branch L_skip5
L_glob5:
    s_mov_b32 s74, 10485760
    s_waitcnt lgkmcnt(1)
    buffer_load_dwordx4 v[168:171], v124, s[20:23], s74 offen sc1
    s_waitcnt lgkmcnt(0)
    buffer_load_dwordx4 v[172:175], v125, s[20:23], s74 offen sc1
L_skip5:
    s_bitcmp1_b32 s68, 6
    s_cbranch_scc0 L_skip6
    s_cmp_eq_u32 s52, 6
    s_cbranch_scc0 L_glob6
    ds_read_b128 v[176:179], v127
    ds_read_b128 v[180:183], v127 offset:512
    s_branch L_skip6
L_glob6:
    s_mov_b32 s74, 12582912
    s_waitcnt lgkmcnt(1)
    buffer_load_dwordx4 v[176:179], v124, s[20:23], s74 offen sc1
    s_waitcnt lgkmcnt(0)
    buffer_load_dwordx4 v[180:183], v125, s[20:23], s74 offen sc1
L_skip6:
    s_bitcmp1_b32 s68, 7
    s_cbranch_scc0 L_skip7
    s_cmp_eq_u32 s52, 7
    s_cbranch_scc0 L_glob7
    ds_read_b128 v[184:187], v127
    ds_read_b128 v[188:191], v127 offset:512
    s_branch L_skip7
L_glob7:
    s_mov_b32 s74, 14680064
    s_waitcnt lgkmcnt(1)
    buffer_load_dwordx4 v[184:187], v124, s[20:23], s74 offen sc1
    s_waitcnt lgkmcnt(0)
    buffer_load_dwordx4 v[188:191], v125, s[20:23], s74 offen sc1
L_skip7:
    s_or_b32 s67, s67, s66
    s_cmp_eq_u32 s67, 0xff
    s_cbranch_scc1 L_fpolled
    s_cmp_lt_u32 s76, 0x40000
    s_cbranch_scc1 L_fpoll
L_fpolled:
    s_cmp_eq_u32 s78, 1
    s_cbranch_scc0 L_nofixld
    s_and_b32 s74, s79, 7
    v_lshrrev_b32 v12, 2, v0
    v_lshrrev_b32 v13, 4, v12
    v_lshlrev_b32 v94, 14, v13
    v_and_b32 v13, 3, v12
    v_lshlrev_b32 v13, 10, v13
    v_add_u32 v94, v94, v13
    v_bfe_u32 v13, v12, 2, 2
    v_lshlrev_b32 v13, 8, v13
    v_add_u32 v94, v94, v13
    v_and_b32 v13, 3, v0
    v_lshlrev_b32 v13, 2, v13
    v_add_u32 v94, v94, v13
    s_lshl_b32 s75, s53, 16
    s_lshr_b32 s76, s52, 1
    s_lshl_b32 s76, s76, 12
    s_add_u32 s75, s75, s76
    s_and_b32 s76, s52, 1
    s_lshl_b32 s76, s76, 3
    s_add_u32 s76, s76, s74
    s_lshl_b32 s76, s76, 4
    s_add_u32 s75, s75, s76
    v_add_u32 v94, s75, v94
    s_mov_b32 s76, 0x7ffffff0
    s_mov_b32 s75, 0
    s_cmp_eq_u32 s52, 0
    s_cselect_b32 s75, s76, s75
    buffer_load_dword v64, v94, s[20:23], s75 offen sc1
    s_mov_b32 s75, 2097152
    s_cmp_eq_u32 s52, 1
    s_cselect_b32 s75, s76, s75
    buffer_load_dword v65, v94, s[20:23], s75 offen sc1
    s_mov_b32 s75, 4194304
    s_cmp_eq_u32 s52, 2
    s_cselect_b32 s75, s76, s75
    buffer_load_dword v66, v94, s[20:23], s75 offen sc1
    s_mov_b32 s75, 6291456
    s_cmp_eq_u32 s52, 3
    s_cselect_b32 s75, s76, s75
    buffer_load_dword v67, v94, s[20:23], s75 offen sc1
    s_mov_b32 s75, 8388608
    s_cmp_eq_u32 s52, 4
    s_cselect_b32 s75, s76, s75
    buffer_load_dword v68, v94, s[20:23], s75 offen sc1
    s_mov_b32 s75, 10485760
    s_cmp_eq_u32 s52, 5
    s_cselect_b32 s75, s76, s75
    buffer_load_dword v69, v94, s[20:23], s75 offen sc1
    s_mov_b32 s75, 12582912
    s_cmp_eq_u32 s52, 6
    s_cselect_b32 s75, s76, s75
    buffer_load_dword v70, v94, s[20:23], s75 offen sc1
    s_mov_b32 s75, 14680064
    s_cmp_eq_u32 s52, 7
    s_cselect_b32 s75, s76, s75
    buffer_load_dword v71, v94, s[20:23], s75 offen sc1
    v_lshlrev_b32 v94, 2, v0
    s_lshl_b32 s75, s79, 10
    buffer_load_dword v88, v94, s[8:11], s75 offen
    s_mul_i32 s75, s74, 1040
    s_add_u32 s75, s75, 67840
    v_add_u32 v12, s75, v94
    ds_read_b32 v89, v12
    s_lshl_b32 s75, s74, 4
    s_add_u32 s75, s75, 67328
    v_mov_b32 v12, s75
    ds_read_b96 v[90:92], v12
L_nofixld:
    s_waitcnt vmcnt(0) lgkmcnt(0)
    s_mov_b32 s74, 0x00003f80
    s_mov_b32 s75, 0x3f800000
    v_lshlrev_b32 v192, 16, v128
    v_and_b32 v193, s63, v128
    v_lshlrev_b32 v194, 16, v129
    v_and_b32 v195, s63, v129
    v_lshlrev_b32 v196, 16, v130
    v_and_b32 v197, s63, v130
    v_lshlrev_b32 v198, 16, v131
    v_and_b32 v199, s63, v131
    v_lshlrev_b32 v200, 16, v132
    v_and_b32 v201, s63, v132
    v_lshlrev_b32 v202, 16, v133
    v_and_b32 v203, s63, v133
    v_lshlrev_b32 v204, 16, v134
    v_and_b32 v205, s63, v134
    v_lshlrev_b32 v206, 16, v135
    v_and_b32 v207, s63, v135
    v_dot2c_f32_bf16 v192, s74, v136
    v_dot2c_f32_bf16 v193, s75, v136
    v_dot2c_f32_bf16 v194, s74, v137
    v_dot2c_f32_bf16 v195, s75, v137
    v_dot2c_f32_bf16 v196, s74, v138
    v_dot2c_f32_bf16 v197, s75, v138
    v_dot2c_f32_bf16 v198, s74, v139
    v_dot2c_f32_bf16 v199, s75, v139
    v_dot2c_f32_bf16 v200, s74, v140
    v_dot2c_f32_bf16 v201, s75, v140
    v_dot2c_f32_bf16 v202, s74, v141
    v_dot2c_f32_bf16 v203, s75, v141
    v_dot2c_f32_bf16 v204, s74, v142
    v_dot2c_f32_bf16 v205, s75, v142
    v_dot2c_f32_bf16 v206, s74, v143
    v_dot2c_f32_bf16 v207, s75, v143
    v_dot2c_f32_bf16 v192, s74, v144
    v_dot2c_f32_bf16 v193, s75, v144
    v_dot2c_f32_bf16 v194, s74, v145
    v_dot2c_f32_bf16 v195, s75, v145
    v_dot2c_f32_bf16 v196, s74, v146
    v_dot2c_f32_bf16 v197, s75, v146
    v_dot2c_f32_bf16 v198, s74, v147
    v_dot2c_f32_bf16 v199, s75, v147
    v_dot2c_f32_bf16 v200, s74, v148
    v_dot2c_f32_bf16 v201, s75, v148
    v_dot2c_f32_bf16 v202, s74, v149
    v_dot2c_f32_bf16 v203, s75, v149
    v_dot2c_f32_bf16 v204, s74, v150
    v_dot2c_f32_bf16 v205, s75, v150
    v_dot2c_f32_bf16 v206, s74, v151
    v_dot2c_f32_bf16 v207, s75, v151
    v_dot2c_f32_bf16 v192, s74, v152
    v_dot2c_f32_bf16 v193, s75, v152
    v_dot2c_f32_bf16 v194, s74, v153
    v_dot2c_f32_bf16 v195, s75, v153
    v_dot2c_f32_bf16 v196, s74, v154
    v_dot2c_f32_bf16 v197, s75, v154
    v_dot2c_f32_bf16 v198, s74, v155
    v_dot2c_f32_bf16 v199, s75, v155
    v_dot2c_f32_bf16 v200, s74, v156
    v_dot2c_f32_bf16 v201, s75, v156
    v_dot2c_f32_bf16 v202, s74, v157
    v_dot2c_f32_bf16 v203, s75, v157
    v_dot2c_f32_bf16 v204, s74, v158
    v_dot2c_f32_bf16 v205, s75, v158
    v_dot2c_f32_bf16 v206, s74, v159
    v_dot2c_f32_bf16 v207, s75, v159
    v_dot2c_f32_bf16 v192, s74, v160
    v_dot2c_f32_bf16 v193, s75, v160
    v_dot2c_f32_bf16 v194, s74, v161
    v_dot2c_f32_bf16 v195, s75, v161
    v_dot2c_f32_bf16 v196, s74, v162
    v_dot2c_f32_bf16 v197, s75, v162
    v_dot2c_f32_bf16 v198, s74, v163
    v_dot2c_f32_bf16 v199, s75, v163
    v_dot2c_f32_bf16 v200, s74, v164
    v_dot2c_f32_bf16 v201, s75, v164
    v_dot2c_f32_bf16 v202, s74, v165
    v_dot2c_f32_bf16 v203, s75, v165
    v_dot2c_f32_bf16 v204, s74, v166
    v_dot2c_f32_bf16 v205, s75, v166
    v_dot2c_f32_bf16 v206, s74, v167
    v_dot2c_f32_bf16 v207, s75, v167
    v_dot2c_f32_bf16 v192, s74, v168
    v_dot2c_f32_bf16 v193, s75, v168
    v_dot2c_f32_bf16 v194, s74, v169
    v_dot2c_f32_bf16 v195, s75, v169
    v_dot2c_f32_bf16 v196, s74, v170
    v_dot2c_f32_bf16 v197, s75, v170
    v_dot2c_f32_bf16 v198, s74, v171
    v_dot2c_f32_bf16 v199, s75, v171
    v_dot2c_f32_bf16 v200, s74, v172
    v_dot2c_f32_bf16 v201, s75, v172
    v_dot2c_f32_bf16 v202, s74, v173
    v_dot2c_f32_bf16 v203, s75, v173
    v_dot2c_f32_bf16 v204, s74, v174
    v_dot2c_f32_bf16 v205, s75, v174
    v_dot2c_f32_bf16 v206, s74, v175
    v_dot2c_f32_bf16 v207, s75, v175
    v_dot2c_f32_bf16 v192, s74, v176
    v_dot2c_f32_bf16 v193, s75, v176
    v_dot2c_f32_bf16 v194, s74, v177
    v_dot2c_f32_bf16 v195, s75, v177
    v_dot2c_f32_bf16 v196, s74, v178
    v_dot2c_f32_bf16 v197, s75, v178
    v_dot2c_f32_bf16 v198, s74, v179
    v_dot2c_f32_bf16 v199, s75, v179
    v_dot2c_f32_bf16 v200, s74, v180
    v_dot2c_f32_bf16 v201, s75, v180
    v_dot2c_f32_bf16 v202, s74, v181
    v_dot2c_f32_bf16 v203, s75, v181
    v_dot2c_f32_bf16 v204, s74, v182
    v_dot2c_f32_bf16 v205, s75, v182
    v_dot2c_f32_bf16 v206, s74, v183
    v_dot2c_f32_bf16 v207, s75, v183
    v_dot2c_f32_bf16 v192, s74, v184
    v_dot2c_f32_bf16 v193, s75, v184
    v_dot2c_f32_bf16 v194, s74, v185
    v_dot2c_f32_bf16 v195, s75, v185
    v_dot2c_f32_bf16 v196, s74, v186
    v_dot2c_f32_bf16 v197, s75, v186
    v_dot2c_f32_bf16 v198, s74, v187
    v_dot2c_f32_bf16 v199, s75, v187
    v_dot2c_f32_bf16 v200, s74, v188
    v_dot2c_f32_bf16 v201, s75, v188
    v_dot2c_f32_bf16 v202, s74, v189
    v_dot2c_f32_bf16 v203, s75, v189
    v_dot2c_f32_bf16 v204, s74, v190
    v_dot2c_f32_bf16 v205, s75, v190
    v_dot2c_f32_bf16 v206, s74, v191
    v_dot2c_f32_bf16 v207, s75, v191
    v_cvt_pk_bf16_f32 v208, v192, v193
    v_lshlrev_b32 v211, 16, v232
    v_and_b32 v212, s63, v232
    v_lshlrev_b32 v209, 16, v208
    v_and_b32 v210, s63, v208
    v_mul_f32 v211, v209, v211
    v_mul_f32 v212, v210, v212
    v_lshlrev_b32 v213, 16, v96
    v_cvt_pk_bf16_f32 v208, v211, v212
    v_and_b32 v214, s63, v96
    v_lshlrev_b32 v211, 16, v208
    v_and_b32 v212, s63, v208
    v_add_f32 v213, v213, v211
    v_add_f32 v214, v214, v212
    v_cvt_pk_bf16_f32 v224, v213, v214
    v_cvt_pk_bf16_f32 v216, v194, v195
    v_lshlrev_b32 v219, 16, v233
    v_and_b32 v220, s63, v233
    v_lshlrev_b32 v217, 16, v216
    v_and_b32 v218, s63, v216
    v_mul_f32 v219, v217, v219
    v_mul_f32 v220, v218, v220
    v_lshlrev_b32 v221, 16, v97
    v_cvt_pk_bf16_f32 v216, v219, v220
    v_and_b32 v222, s63, v97
    v_lshlrev_b32 v219, 16, v216
    v_and_b32 v220, s63, v216
    v_add_f32 v221, v221, v219
    v_add_f32 v222, v222, v220
    v_cvt_pk_bf16_f32 v225, v221, v222
    v_cvt_pk_bf16_f32 v208, v196, v197
    v_lshlrev_b32 v211, 16, v234
    v_and_b32 v212, s63, v234
    v_lshlrev_b32 v209, 16, v208
    v_and_b32 v210, s63, v208
    v_mul_f32 v211, v209, v211
    v_mul_f32 v212, v210, v212
    v_lshlrev_b32 v213, 16, v98
    v_cvt_pk_bf16_f32 v208, v211, v212
    v_and_b32 v214, s63, v98
    v_lshlrev_b32 v211, 16, v208
    v_and_b32 v212, s63, v208
    v_add_f32 v213, v213, v211
    v_add_f32 v214, v214, v212
    v_cvt_pk_bf16_f32 v226, v213, v214
    v_cvt_pk_bf16_f32 v216, v198, v199
    v_lshlrev_b32 v219, 16, v235
    v_and_b32 v220, s63, v235
    v_lshlrev_b32 v217, 16, v216
    v_and_b32 v218, s63, v216
    v_mul_f32 v219, v217, v219
    v_mul_f32 v220, v218, v220
    v_lshlrev_b32 v221, 16, v99
    v_cvt_pk_bf16_f32 v216, v219, v220
    v_and_b32 v222, s63, v99
    v_lshlrev_b32 v219, 16, v216
    v_and_b32 v220, s63, v216
    v_add_f32 v221, v221, v219
    v_add_f32 v222, v222, v220
    v_cvt_pk_bf16_f32 v227, v221, v222
    buffer_store_dwordx4 v[224:227], v123, s[24:27], 0 offen offset:0
    v_cvt_pk_bf16_f32 v208, v200, v201
    v_lshlrev_b32 v211, 16, v236
    v_and_b32 v212, s63, v236
    v_lshlrev_b32 v209, 16, v208
    v_and_b32 v210, s63, v208
    v_mul_f32 v211, v209, v211
    v_mul_f32 v212, v210, v212
    v_lshlrev_b32 v213, 16, v100
    v_cvt_pk_bf16_f32 v208, v211, v212
    v_and_b32 v214, s63, v100
    v_lshlrev_b32 v211, 16, v208
    v_and_b32 v212, s63, v208
    v_add_f32 v213, v213, v211
    v_add_f32 v214, v214, v212
    v_cvt_pk_bf16_f32 v228, v213, v214
    v_cvt_pk_bf16_f32 v216, v202, v203
    v_lshlrev_b32 v219, 16, v237
    v_and_b32 v220, s63, v237
    v_lshlrev_b32 v217, 16, v216
    v_and_b32 v218, s63, v216
    v_mul_f32 v219, v217, v219
    v_mul_f32 v220, v218, v220
    v_lshlrev_b32 v221, 16, v101
    v_cvt_pk_bf16_f32 v216, v219, v220
    v_and_b32 v222, s63, v101
    v_lshlrev_b32 v219, 16, v216
    v_and_b32 v220, s63, v216
    v_add_f32 v221, v221, v219
    v_add_f32 v222, v222, v220
    v_cvt_pk_bf16_f32 v229, v221, v222
    v_cvt_pk_bf16_f32 v208, v204, v205
    v_lshlrev_b32 v211, 16, v238
    v_and_b32 v212, s63, v238
    v_lshlrev_b32 v209, 16, v208
    v_and_b32 v210, s63, v208
    v_mul_f32 v211, v209, v211
    v_mul_f32 v212, v210, v212
    v_lshlrev_b32 v213, 16, v102
    v_cvt_pk_bf16_f32 v208, v211, v212
    v_and_b32 v214, s63, v102
    v_lshlrev_b32 v211, 16, v208
    v_and_b32 v212, s63, v208
    v_add_f32 v213, v213, v211
    v_add_f32 v214, v214, v212
    v_cvt_pk_bf16_f32 v230, v213, v214
    v_cvt_pk_bf16_f32 v216, v206, v207
    v_lshlrev_b32 v219, 16, v239
    v_and_b32 v220, s63, v239
    v_lshlrev_b32 v217, 16, v216
    v_and_b32 v218, s63, v216
    v_mul_f32 v219, v217, v219
    v_mul_f32 v220, v218, v220
    v_lshlrev_b32 v221, 16, v103
    v_cvt_pk_bf16_f32 v216, v219, v220
    v_and_b32 v222, s63, v103
    v_lshlrev_b32 v219, 16, v216
    v_and_b32 v220, s63, v216
    v_add_f32 v221, v221, v219
    v_add_f32 v222, v222, v220
    v_cvt_pk_bf16_f32 v231, v221, v222
    buffer_store_dwordx4 v[228:231], v123, s[24:27], 0 offen offset:512
    s_cmp_eq_u32 s78, 1
    s_cbranch_scc0 L_nofix
    s_mov_b32 s77, 0
L_ypoll:
    s_cmp_eq_u32 s70, 1
    s_cbranch_scc1 L_yok
    buffer_load_dwordx4 v[192:195], v14, s[20:23], 0 offen sc1
    s_waitcnt vmcnt(0)
    v_xor_b32 v192, s83, v192
    v_xor_b32 v193, s83, v193
    v_xor_b32 v194, s83, v194
    v_xor_b32 v195, s83, v195
    v_or_b32 v192, v192, v193
    v_or3_b32 v192, v192, v194, v195
    v_cmp_ne_u32 vcc, 0, v192
    s_nop 4
    s_cmp_eq_u64 vcc, 0
    s_cselect_b32 s74, 1, 0
    s_andn2_b32 s74, s74, s70
    s_cmp_eq_u32 s74, 1
    s_cbranch_scc0 L_noyb
    s_mov_b32 s70, 1
    v_lshlrev_b32 v11, 3, v0
    s_mov_b32 s75, 18874368
    buffer_load_dwordx2 v[72:73], v11, s[20:23], s75 offen offset:0 sc1
    buffer_load_dwordx2 v[74:75], v11, s[20:23], s75 offen offset:2048 sc1
    s_add_u32 s75, s75, 4096
    buffer_load_dwordx2 v[76:77], v11, s[20:23], s75 offen offset:0 sc1
    buffer_load_dwordx2 v[78:79], v11, s[20:23], s75 offen offset:2048 sc1
    s_add_u32 s75, s75, 4096
    buffer_load_dwordx2 v[80:81], v11, s[20:23], s75 offen offset:0 sc1
    buffer_load_dwordx2 v[82:83], v11, s[20:23], s75 offen offset:2048 sc1
    s_add_u32 s75, s75, 4096
    buffer_load_dwordx2 v[84:85], v11, s[20:23], s75 offen offset:0 sc1
    buffer_load_dwordx2 v[86:87], v11, s[20:23], s75 offen offset:2048 sc1
L_noyb:
    s_add_u32 s77, s77, 1
    s_cmp_lt_u32 s77, 0x40000
    s_cbranch_scc1 L_ypoll
L_yok:
    s_waitcnt vmcnt(0)
    s_mov_b32 s74, 0x00003f80
    s_mov_b32 s75, 0x3f800000
    v_pk_add_f32 v[72:73], v[72:73], v[74:75]
    v_pk_add_f32 v[76:77], v[76:77], v[78:79]
    v_pk_add_f32 v[80:81], v[80:81], v[82:83]
    v_pk_add_f32 v[84:85], v[84:85], v[86:87]
    v_pk_add_f32 v[72:73], v[72:73], v[76:77]
    v_pk_add_f32 v[80:81], v[80:81], v[84:85]
    v_pk_add_f32 v[72:73], v[72:73], v[80:81]
    s_lshr_b32 s76, s85, 16
    s_and_b32 s77, s76, 0x8000
    s_cmp_lg_u32 s77, 0
    s_mov_b32 s68, 0xffff
    s_cselect_b32 s77, 0x8000, s68
    s_xor_b32 s76, s76, s77
    s_lshl_b32 s76, s76, 16
    v_mov_b32 v12, s76
    v_mul_f32 v12, 0xbfb8aa3b, v12
    v_exp_f32 v12, v12
    s_nop 0
    v_add_f32 v12, 1.0, v12
    v_rcp_f32 v12, v12
    s_nop 0
    v_cvt_pk_bf16_f32 v12, v12, v12
    v_and_b32 v12, s63, v12
    v_cvt_pk_bf16_f32 v14, v72, v73
    v_lshlrev_b32 v72, 16, v14
    v_and_b32 v73, s63, v14
    v_mul_f32 v72, v72, v12
    v_mul_f32 v73, v73, v12
    v_cvt_pk_bf16_f32 v14, v72, v73
    v_lshlrev_b32 v72, 16, v14
    v_and_b32 v73, s63, v14
    v_lshlrev_b32 v200, 16, v89
    v_and_b32 v201, s63, v89
    v_dot2c_f32_bf16 v200, s74, v64
    v_dot2c_f32_bf16 v201, s75, v64
    v_dot2c_f32_bf16 v200, s74, v65
    v_dot2c_f32_bf16 v201, s75, v65
    v_dot2c_f32_bf16 v200, s74, v66
    v_dot2c_f32_bf16 v201, s75, v66
    v_dot2c_f32_bf16 v200, s74, v67
    v_dot2c_f32_bf16 v201, s75, v67
    v_dot2c_f32_bf16 v200, s74, v68
    v_dot2c_f32_bf16 v201, s75, v68
    v_dot2c_f32_bf16 v200, s74, v69
    v_dot2c_f32_bf16 v201, s75, v69
    v_dot2c_f32_bf16 v200, s74, v70
    v_dot2c_f32_bf16 v201, s75, v70
    v_dot2c_f32_bf16 v200, s74, v71
    v_dot2c_f32_bf16 v201, s75, v71
    v_lshlrev_b32 v213, 16, v88
    v_and_b32 v214, s63, v88
    v_sub_f32 v209, v213, v90
    v_sub_f32 v210, v214, v90
    v_fma_f32 v209, v209, v91, v92
    v_fma_f32 v210, v210, v91, v92
    v_cvt_pk_bf16_f32 v208, v209, v210
    v_lshlrev_b32 v209, 16, v208
    v_and_b32 v210, s63, v208
    v_add_f32 v209, v209, v72
    v_add_f32 v210, v210, v73
    v_cvt_pk_bf16_f32 v208, v209, v210
    v_lshlrev_b32 v209, 16, v208
    v_and_b32 v210, s63, v208
    v_mul_f32 v211, 0xbfb8aa3b, v209
    v_mul_f32 v212, 0xbfb8aa3b, v210
    v_exp_f32 v211, v211
    v_exp_f32 v212, v212
    s_nop 0
    v_add_f32 v211, 1.0, v211
    v_add_f32 v212, 1.0, v212
    v_rcp_f32 v211, v211
    v_rcp_f32 v212, v212
    v_cvt_pk_bf16_f32 v208, v200, v201
    v_mul_f32 v211, v209, v211
    v_mul_f32 v212, v210, v212
    v_lshlrev_b32 v200, 16, v208
    v_and_b32 v201, s63, v208
    v_cvt_pk_bf16_f32 v208, v211, v212
    v_lshlrev_b32 v211, 16, v208
    v_and_b32 v212, s63, v208
    v_mul_f32 v211, v200, v211
    v_mul_f32 v212, v201, v212
    v_cvt_pk_bf16_f32 v208, v211, v212
    v_lshlrev_b32 v211, 16, v208
    v_and_b32 v212, s63, v208
    v_add_f32 v213, v213, v211
    v_add_f32 v214, v214, v212
    v_cvt_pk_bf16_f32 v208, v213, v214
    s_lshl_b32 s76, s79, 10
    buffer_store_dword v208, v94, s[24:27], s76 offen
L_nofix:
    s_branch L_fin
L_fallback:
    s_mov_b32 s72, 1
    v_mov_b32 v12, 0xff800000
    v_mov_b32 v13, 0xff800000
    s_mov_b32 s64, 0
    v_subrev_u32 v4, 16768, v4
    v_add_u32 v15, 4096, v6
L_fb_loop:
    s_waitcnt vmcnt(0) lgkmcnt(0)
    s_barrier
    s_add_u32 m0, s70, 0
    s_nop 0
    buffer_load_dwordx4 v5, s[12:15], s64 offen lds
    s_add_u32 m0, m0, 16
    s_nop 0
    buffer_load_dwordx4 v5, s[12:15], s64 offen offset:1024 lds
    s_waitcnt vmcnt(0)
    s_barrier
    ds_read_b128 a[0:3], v2 offset:0
    s_waitcnt lgkmcnt(0)
    v_mfma_f32_32x32x16_bf16 v[192:207], a[0:3], v[128:131], 0
    v_mfma_f32_32x32x16_bf16 v[208:223], a[0:3], v[160:163], 0
    s_nop 7
    ds_read_b128 a[0:3], v2 offset:16
    s_waitcnt lgkmcnt(0)
    v_mfma_f32_32x32x16_bf16 v[192:207], a[0:3], v[132:135], v[192:207]
    v_mfma_f32_32x32x16_bf16 v[208:223], a[0:3], v[164:167], v[208:223]
    s_nop 7
    ds_read_b128 a[0:3], v2 offset:32
    s_waitcnt lgkmcnt(0)
    v_mfma_f32_32x32x16_bf16 v[192:207], a[0:3], v[136:139], v[192:207]
    v_mfma_f32_32x32x16_bf16 v[208:223], a[0:3], v[168:171], v[208:223]
    s_nop 7
    ds_read_b128 a[0:3], v2 offset:48
    s_waitcnt lgkmcnt(0)
    v_mfma_f32_32x32x16_bf16 v[192:207], a[0:3], v[140:143], v[192:207]
    v_mfma_f32_32x32x16_bf16 v[208:223], a[0:3], v[172:175], v[208:223]
    s_nop 7
    ds_read_b128 a[0:3], v3 offset:0
    s_waitcnt lgkmcnt(0)
    v_mfma_f32_32x32x16_bf16 v[192:207], a[0:3], v[144:147], v[192:207]
    v_mfma_f32_32x32x16_bf16 v[208:223], a[0:3], v[176:179], v[208:223]
    s_nop 7
    ds_read_b128 a[0:3], v3 offset:16
    s_waitcnt lgkmcnt(0)
    v_mfma_f32_32x32x16_bf16 v[192:207], a[0:3], v[148:151], v[192:207]
    v_mfma_f32_32x32x16_bf16 v[208:223], a[0:3], v[180:183], v[208:223]
    s_nop 7
    ds_read_b128 a[0:3], v3 offset:32
    s_waitcnt lgkmcnt(0)
    v_mfma_f32_32x32x16_bf16 v[192:207], a[0:3], v[152:155], v[192:207]
    v_mfma_f32_32x32x16_bf16 v[208:223], a[0:3], v[184:187], v[208:223]
    s_nop 7
    ds_read_b128 a[0:3], v3 offset:48
    s_waitcnt lgkmcnt(0)
    v_mfma_f32_32x32x16_bf16 v[192:207], a[0:3], v[156:159], v[192:207]
    v_mfma_f32_32x32x16_bf16 v[208:223], a[0:3], v[188:191], v[208:223]
    s_nop 7
    s_nop 15
    v_max3_f32 v12, v12, v192, v193
    v_max3_f32 v12, v12, v194, v195
    v_max3_f32 v12, v12, v196, v197
    v_max3_f32 v12, v12, v198, v199
    v_max3_f32 v12, v12, v200, v201
    v_max3_f32 v12, v12, v202, v203
    v_max3_f32 v12, v12, v204, v205
    v_max3_f32 v12, v12, v206, v207
    v_max3_f32 v13, v13, v208, v209
    v_max3_f32 v13, v13, v210, v211
    v_max3_f32 v13, v13, v212, v213
    v_max3_f32 v13, v13, v214, v215
    v_max3_f32 v13, v13, v216, v217
    v_max3_f32 v13, v13, v218, v219
    v_max3_f32 v13, v13, v220, v221
    v_max3_f32 v13, v13, v222, v223
    s_add_u32 s64, s64, 8192
    s_cmp_lt_u32 s64, 131072
    s_cbranch_scc1 L_fb_loop
    v_mov_b32 v8, v12
    v_mov_b32 v9, v13
    s_nop 1
    v_permlane32_swap_b32 v12, v8
    v_permlane32_swap_b32 v13, v9
    v_max_f32 v12, v12, v8
    v_max_f32 v13, v13, v9
    v_accvgpr_write_b32 a221, v12
    v_accvgpr_write_b32 a222, v13
    v_accvgpr_write_b32 a64, 0
    v_accvgpr_write_b32 a65, 0
    v_accvgpr_write_b32 a66, 0
    v_accvgpr_write_b32 a67, 0
    v_accvgpr_write_b32 a68, 0
    v_accvgpr_write_b32 a69, 0
    v_accvgpr_write_b32 a70, 0
    v_accvgpr_write_b32 a71, 0
    v_accvgpr_write_b32 a72, 0
    v_accvgpr_write_b32 a73, 0
    v_accvgpr_write_b32 a74, 0
    v_accvgpr_write_b32 a75, 0
    v_accvgpr_write_b32 a76, 0
    v_accvgpr_write_b32 a77, 0
    v_accvgpr_write_b32 a78, 0
    v_accvgpr_write_b32 a79, 0
    v_accvgpr_write_b32 a80, 0
    v_accvgpr_write_b32 a81, 0
    v_accvgpr_write_b32 a82, 0
    v_accvgpr_write_b32 a83, 0
    v_accvgpr_write_b32 a84, 0
    v_accvgpr_write_b32 a85, 0
    v_accvgpr_write_b32 a86, 0
    v_accvgpr_write_b32 a87, 0
    v_accvgpr_write_b32 a88, 0
    v_accvgpr_write_b32 a89, 0
    v_accvgpr_write_b32 a90, 0
    v_accvgpr_write_b32 a91, 0
    v_accvgpr_write_b32 a92, 0
    v_accvgpr_write_b32 a93, 0
    v_accvgpr_write_b32 a94, 0
    v_accvgpr_write_b32 a95, 0
    v_accvgpr_write_b32 a96, 0
    v_accvgpr_write_b32 a97, 0
    v_accvgpr_write_b32 a98, 0
    v_accvgpr_write_b32 a99, 0
    v_accvgpr_write_b32 a100, 0
    v_accvgpr_write_b32 a101, 0
    v_accvgpr_write_b32 a102, 0
    v_accvgpr_write_b32 a103, 0
    v_accvgpr_write_b32 a104, 0
    v_accvgpr_write_b32 a105, 0
    v_accvgpr_write_b32 a106, 0
    v_accvgpr_write_b32 a107, 0
    v_accvgpr_write_b32 a108, 0
    v_accvgpr_write_b32 a109, 0
    v_accvgpr_write_b32 a110, 0
    v_accvgpr_write_b32 a111, 0
    v_accvgpr_write_b32 a112, 0
    v_accvgpr_write_b32 a113, 0
    v_accvgpr_write_b32 a114, 0
    v_accvgpr_write_b32 a115, 0
    v_accvgpr_write_b32 a116, 0
    v_accvgpr_write_b32 a117, 0
    v_accvgpr_write_b32 a118, 0
    v_accvgpr_write_b32 a119, 0
    v_accvgpr_write_b32 a120, 0
    v_accvgpr_write_b32 a121, 0
    v_accvgpr_write_b32 a122, 0
    v_accvgpr_write_b32 a123, 0
    v_accvgpr_write_b32 a124, 0
    v_accvgpr_write_b32 a125, 0
    v_accvgpr_write_b32 a126, 0
    v_accvgpr_write_b32 a127, 0
    v_accvgpr_write_b32 a128, 0
    v_accvgpr_write_b32 a129, 0
    v_accvgpr_write_b32 a130, 0
    v_accvgpr_write_b32 a131, 0
    v_accvgpr_write_b32 a132, 0
    v_accvgpr_write_b32 a133, 0
    v_accvgpr_write_b32 a134, 0
    v_accvgpr_write_b32 a135, 0
    v_accvgpr_write_b32 a136, 0
    v_accvgpr_write_b32 a137, 0
    v_accvgpr_write_b32 a138, 0
    v_accvgpr_write_b32 a139, 0
    v_accvgpr_write_b32 a140, 0
    v_accvgpr_write_b32 a141, 0
    v_accvgpr_write_b32 a142, 0
    v_accvgpr_write_b32 a143, 0
    v_accvgpr_write_b32 a144, 0
    v_accvgpr_write_b32 a145, 0
    v_accvgpr_write_b32 a146, 0
    v_accvgpr_write_b32 a147, 0
    v_accvgpr_write_b32 a148, 0
    v_accvgpr_write_b32 a149, 0
    v_accvgpr_write_b32 a150, 0
    v_accvgpr_write_b32 a151, 0
    v_accvgpr_write_b32 a152, 0
    v_accvgpr_write_b32 a153, 0
    v_accvgpr_write_b32 a154, 0
    v_accvgpr_write_b32 a155, 0
    v_accvgpr_write_b32 a156, 0
    v_accvgpr_write_b32 a157, 0
    v_accvgpr_write_b32 a158, 0
    v_accvgpr_write_b32 a159, 0
    v_accvgpr_write_b32 a160, 0
    v_accvgpr_write_b32 a161, 0
    v_accvgpr_write_b32 a162, 0
    v_accvgpr_write_b32 a163, 0
    v_accvgpr_write_b32 a164, 0
    v_accvgpr_write_b32 a165, 0
    v_accvgpr_write_b32 a166, 0
    v_accvgpr_write_b32 a167, 0
    v_accvgpr_write_b32 a168, 0
    v_accvgpr_write_b32 a169, 0
    v_accvgpr_write_b32 a170, 0
    v_accvgpr_write_b32 a171, 0
    v_accvgpr_write_b32 a172, 0
    v_accvgpr_write_b32 a173, 0
    v_accvgpr_write_b32 a174, 0
    v_accvgpr_write_b32 a175, 0
    v_accvgpr_write_b32 a176, 0
    v_accvgpr_write_b32 a177, 0
    v_accvgpr_write_b32 a178, 0
    v_accvgpr_write_b32 a179, 0
    v_accvgpr_write_b32 a180, 0
    v_accvgpr_write_b32 a181, 0
    v_accvgpr_write_b32 a182, 0
    v_accvgpr_write_b32 a183, 0
    v_accvgpr_write_b32 a184, 0
    v_accvgpr_write_b32 a185, 0
    v_accvgpr_write_b32 a186, 0
    v_accvgpr_write_b32 a187, 0
    v_accvgpr_write_b32 a188, 0
    v_accvgpr_write_b32 a189, 0
    v_accvgpr_write_b32 a190, 0
    v_accvgpr_write_b32 a191, 0
    s_waitcnt vmcnt(0) lgkmcnt(0)
    s_barrier
    s_mov_b32 s64, 0
    s_add_u32 m0, s70, 0
    s_nop 0
    buffer_load_dwordx4 v5, s[12:15], s64 offen lds
    s_add_u32 m0, m0, 16
    s_nop 0
    buffer_load_dwordx4 v5, s[12:15], s64 offen offset:1024 lds
    s_add_u32 s64, s64, 8192
    s_add_u32 m0, s70, 8320
    s_nop 0
    buffer_load_dwordx4 v5, s[12:15], s64 offen lds
    s_add_u32 m0, m0, 16
    s_nop 0
    buffer_load_dwordx4 v5, s[12:15], s64 offen offset:1024 lds
    s_add_u32 s64, s64, 8192
    s_add_u32 m0, s71, 0
    s_nop 0
    buffer_load_dwordx4 v6, s[16:19], s64 offen lds
    s_add_u32 m0, m0, 1024
    s_nop 0
    buffer_load_dwordx4 v15, s[16:19], s64 offen lds
    s_add_u32 m0, s70, 16640
    s_nop 0
    buffer_load_dwordx4 v5, s[12:15], s64 offen lds
    s_add_u32 m0, m0, 16
    s_nop 0
    buffer_load_dwordx4 v5, s[12:15], s64 offen offset:1024 lds
    s_add_u32 s64, s64, 8192
    s_add_u32 m0, s71, 8384
    s_nop 0
    buffer_load_dwordx4 v6, s[16:19], s64 offen lds
    s_add_u32 m0, m0, 1024
    s_nop 0
    buffer_load_dwordx4 v15, s[16:19], s64 offen lds
    s_add_u32 m0, s70, 24960
    s_nop 0
    buffer_load_dwordx4 v5, s[12:15], s64 offen lds
    s_add_u32 m0, m0, 16
    s_nop 0
    buffer_load_dwordx4 v5, s[12:15], s64 offen offset:1024 lds
    s_add_u32 s64, s64, 8192
    s_waitcnt vmcnt(0)
    s_branch L_attn
L_fin:
L_end:
    s_endpgm

.section .rodata,"a"
.p2align 6
.amdhsa_kernel recurrent_scan__sliding_block_cached__moe_arch_mod__prompt_kernel
  .amdhsa_next_free_vgpr 512
  .amdhsa_next_free_sgpr 102
  .amdhsa_accum_offset 256
  .amdhsa_group_segment_fixed_size 0
  .amdhsa_kernarg_size 104
  .amdhsa_user_sgpr_count 2
  .amdhsa_user_sgpr_kernarg_segment_ptr 1
  .amdhsa_system_sgpr_workgroup_id_x 1
  .amdhsa_float_denorm_mode_32 3
.end_amdhsa_kernel
```
